```python
import torch

def _softmax(x, axis=-1):
    return torch.softmax(x, dim=axis)
def _gelu(x):
    return torch.nn.functional.gelu(x, approximate="tanh")
def _silu(x):
    return torch.nn.functional.silu(x)
def _sigmoid(x):
    return torch.sigmoid(x)
def _layernorm(x, axis=-1, eps=1e-5):
    m = x.mean(dim=axis, keepdim=True)
    v = x.var(dim=axis, keepdim=True, unbiased=False)
    return (x - m) / torch.sqrt(v + eps)
def _scatter_add(tgt, idx, src, axis=0):
    return tgt.clone().index_add_(axis, idx, src)
def _segment_sum(src, seg, n):
    out = torch.zeros((n,) + src.shape[1:], dtype=src.dtype)
    return out.index_add_(0, seg, src)
def _pad(x, pw):
    flat = tuple(v for pair in reversed(pw) for v in pair)
    return torch.nn.functional.pad(x, flat)

kernel_name = 'standalone__low_rank_proj_linformer__sampling'

def setup_inputs():

    _w = (lambda a: (lambda t: t.to(torch.bfloat16) if t.is_floating_point() else t)(torch.as_tensor(a)))
    B, H, Sq, Skv, Dh, R = 8, 32, 8, 2048, 128, 8
    return {
        "q": _w((lambda *s: torch.randn(*s, dtype=torch.bfloat16) * 0.8)(B, H, Sq, Dh)),
        "k": _w((lambda *s: torch.randn(*s, dtype=torch.bfloat16) * 0.8)(B, H, Skv, Dh)),
        "v": _w((lambda *s: torch.randn(*s, dtype=torch.bfloat16) * 0.05)(B, H, Skv, Dh)),
        "e_proj": _w((lambda *s: torch.randn(*s, dtype=torch.bfloat16) * 0.8)(R, Skv) * (Skv ** -0.5)),
        "f_proj": _w((lambda *s: torch.randn(*s, dtype=torch.bfloat16) * 0.05)(R, Skv) * (Skv ** -0.5)),
    }

def reference(q, k, v, e_proj, f_proj):
    B, H, Sq, Dh = q.shape
    kp = torch.einsum("rn,bhnd->bhrd", e_proj, k)
    vp = torch.einsum("rn,bhnd->bhrd", f_proj, v)
    scores = torch.einsum("bhqd,bhrd->bhqr", q, kp) * (Dh ** -0.5)
    p = _softmax(scores, axis=-1)
    o = torch.einsum("bhqr,bhrd->bhqd", p, vp)
    return o
```

```asm
; @launch grid=(256,1,1) block=(256,1,1) lds=24576
.amdgcn_target "amdgcn-amd-amdhsa--gfx950"
.text
.globl standalone__low_rank_proj_linformer__sampling_kernel
.p2align 8
.type standalone__low_rank_proj_linformer__sampling_kernel,@function
standalone__low_rank_proj_linformer__sampling_kernel:
    s_cmp_ge_u32 s2, 256
    s_cbranch_scc1 L_end
    s_load_dwordx8 s[4:11], s[0:1], 0
    s_load_dwordx4 s[12:15], s[0:1], 32
    v_lshrrev_b32 v3, 6, v0
    v_and_b32 v2, 63, v0
    v_readfirstlane_b32 s32, v3
    v_lshrrev_b32 v3, 4, v2
    v_and_b32 v4, 15, v2
    v_lshlrev_b32 v6, 12, v3
    v_lshl_add_u32 v1, v4, 4, v6
    s_lshl_b32 s38, s2, 19
    s_mov_b32 s18, 0x80000
    s_mov_b32 s19, 0x20000
    s_mov_b32 s22, 0x80000
    s_mov_b32 s23, 0x20000
    s_and_b32 s33, s32, 1
    s_lshl_b32 s33, s33, 11
    s_lshr_b32 s37, s32, 1
    s_lshl_b32 s37, s37, 14
    s_add_u32 s33, s33, s37
    s_add_u32 s64, s33, 0
    s_add_u32 s65, s33, 32768
    s_add_u32 s66, s33, 65536
    s_add_u32 s67, s33, 98304
    s_waitcnt lgkmcnt(0)
    s_add_u32 s16, s6, s38
    s_addc_u32 s17, s7, 0
    buffer_load_dwordx4 v[164:167], v1, s[16:19], s64 offen offset:0 nt
    buffer_load_dwordx4 v[168:171], v1, s[16:19], s65 offen offset:0 nt
    buffer_load_dwordx4 v[172:175], v1, s[16:19], s66 offen offset:0 nt
    buffer_load_dwordx4 v[176:179], v1, s[16:19], s67 offen offset:0 nt
    buffer_load_dwordx4 v[180:183], v1, s[16:19], s64 offen offset:256 nt
    s_add_u32 s20, s8, s38
    s_addc_u32 s21, s9, 0
    s_load_dword s39, s[20:21], 0
    s_lshl_b32 s37, s2, 2
    s_add_u32 s37, s37, s32
    s_lshl_b32 s37, s37, 9
    s_add_u32 s78, s4, s37
    s_addc_u32 s79, s5, 0
    s_load_dword s39, s[78:79], 0
    s_load_dword s39, s[78:79], 128
    s_load_dword s39, s[78:79], 256
    s_load_dword s39, s[78:79], 384
    v_lshrrev_b32 v70, 7, v6
    v_cmp_gt_u32 vcc, 8, v4
    v_mov_b32 v6, s12
    v_mov_b32 v7, s13
    v_mov_b32 v68, s10
    v_mov_b32 v69, s11
    v_cndmask_b32 v6, v6, v68, vcc
    v_cndmask_b32 v7, v7, v69, vcc
    v_and_b32 v68, 7, v4
    v_lshl_add_u32 v68, v68, 12, v70
    s_lshr_b32 s37, s33, 7
    v_add_u32 v68, s37, v68
    v_add_co_u32 v6, vcc, v6, v68
    s_mov_b32 s35, 0x05040100
    s_mov_b32 s36, 0x07060302
    v_addc_co_u32 v7, vcc, 0, v7, vcc
    s_lshl_b32 s37, s2, 11
    s_add_u32 s24, s4, s37
    s_addc_u32 s25, s5, 0
    s_mov_b32 s26, 2048
    s_mov_b32 s27, 0x20000
    s_add_u32 s28, s14, s37
    s_addc_u32 s29, s15, 0
    s_mov_b32 s30, 2048
    s_mov_b32 s31, 0x20000
    v_lshlrev_b32 v5, 8, v4
    v_lshl_add_u32 v5, v3, 6, v5
    s_getreg_b32 s37, hwreg(HW_REG_XCC_ID, 0, 1)
    s_cmp_eq_u32 s37, 0
    s_cselect_b64 vcc, -1, 0
    s_mul_i32 s37, s32, 2560
    v_and_b32 v10, 1, v3
    v_lshlrev_b32 v10, 3, v10
    v_lshl_add_u32 v10, v4, 4, v10
    v_add_u32 v10, s37, v10
    v_lshrrev_b32 v11, 1, v3
    v_xor_b32 v11, 1, v11
    v_mul_u32_u24 v11, 10240, v11
    v_add_u32 v10, v10, v11
    v_and_b32 v11, 3, v4
    v_mul_u32_u24 v11, 320, v11
    v_lshrrev_b32 v12, 2, v4
    v_lshl_add_u32 v11, v12, 4, v11
    v_mul_u32_u24 v12, 2560, v3
    v_add_u32 v11, v11, v12
    s_lshl_b32 s37, s32, 6
    v_add_u32 v11, s37, v11
    v_lshlrev_b32 v12, 8, v4
    v_lshl_add_u32 v12, v3, 4, v12
    v_add_u32 v12, s37, v12
    s_waitcnt vmcnt(4)
    buffer_load_dwordx4 v[184:187], v1, s[16:19], s65 offen offset:256 nt
    s_waitcnt vmcnt(4)
    buffer_load_dwordx4 v[188:191], v1, s[16:19], s66 offen offset:256 nt
    s_waitcnt vmcnt(4)
    buffer_load_dwordx4 v[192:195], v1, s[16:19], s67 offen offset:256 nt
    s_waitcnt vmcnt(4)
    buffer_load_dwordx4 v[196:199], v1, s[16:19], s64 offen offset:512 nt
    global_load_dwordx4 v[68:71], v[6:7], off offset:0
    s_waitcnt vmcnt(5)
    buffer_load_dwordx4 v[200:203], v1, s[16:19], s65 offen offset:512 nt
    global_load_dwordx4 v[72:75], v[6:7], off offset:256
    v_perm_b32 v100, v180, v164, s35
    v_perm_b32 v104, v180, v164, s36
    v_perm_b32 v108, v181, v165, s35
    v_perm_b32 v112, v181, v165, s36
    v_perm_b32 v116, v182, v166, s35
    v_perm_b32 v120, v182, v166, s36
    v_perm_b32 v124, v183, v167, s35
    v_perm_b32 v128, v183, v167, s36
    s_waitcnt vmcnt(6)
    buffer_load_dwordx4 v[204:207], v1, s[16:19], s66 offen offset:512 nt
    global_load_dwordx4 v[76:79], v[6:7], off offset:512
    v_perm_b32 v101, v184, v168, s35
    v_perm_b32 v105, v184, v168, s36
    v_perm_b32 v109, v185, v169, s35
    v_perm_b32 v113, v185, v169, s36
    v_perm_b32 v117, v186, v170, s35
    v_perm_b32 v121, v186, v170, s36
    v_perm_b32 v125, v187, v171, s35
    v_perm_b32 v129, v187, v171, s36
    s_waitcnt vmcnt(7)
    buffer_load_dwordx4 v[208:211], v1, s[16:19], s67 offen offset:512 nt
    global_load_dwordx4 v[80:83], v[6:7], off offset:768
    v_perm_b32 v102, v188, v172, s35
    v_perm_b32 v106, v188, v172, s36
    v_perm_b32 v110, v189, v173, s35
    v_perm_b32 v114, v189, v173, s36
    v_perm_b32 v118, v190, v174, s35
    v_perm_b32 v122, v190, v174, s36
    v_perm_b32 v126, v191, v175, s35
    v_perm_b32 v130, v191, v175, s36
    s_waitcnt vmcnt(8)
    buffer_load_dwordx4 v[212:215], v1, s[16:19], s64 offen offset:768 nt
    v_perm_b32 v103, v192, v176, s35
    v_perm_b32 v107, v192, v176, s36
    v_perm_b32 v111, v193, v177, s35
    v_perm_b32 v115, v193, v177, s36
    v_perm_b32 v119, v194, v178, s35
    v_perm_b32 v123, v194, v178, s36
    v_perm_b32 v127, v195, v179, s35
    v_perm_b32 v131, v195, v179, s36
    s_waitcnt vmcnt(8)
    buffer_load_dwordx4 v[216:219], v1, s[16:19], s65 offen offset:768 nt
    s_cbranch_vccnz L_e9
    s_waitcnt vmcnt(7)
L_e9:
    buffer_load_dwordx4 v[220:223], v1, s[16:19], s66 offen offset:768 nt
    s_waitcnt vmcnt(8)
    s_waitcnt vmcnt(6)
    buffer_load_dwordx4 v[224:227], v1, s[16:19], s67 offen offset:768 nt
    v_accvgpr_write_b32 a0, v68
    v_accvgpr_write_b32 a4, v69
    v_accvgpr_write_b32 a8, v70
    v_accvgpr_write_b32 a12, v71
    s_waitcnt vmcnt(5)
    buffer_load_dwordx4 v[164:167], v1, s[16:19], s64 offen offset:1024 nt
    v_accvgpr_write_b32 a1, v72
    v_accvgpr_write_b32 a5, v73
    v_accvgpr_write_b32 a9, v74
    v_accvgpr_write_b32 a13, v75
    s_waitcnt vmcnt(4)
    buffer_load_dwordx4 v[168:171], v1, s[16:19], s65 offen offset:1024 nt
    v_accvgpr_write_b32 a2, v76
    v_accvgpr_write_b32 a6, v77
    v_accvgpr_write_b32 a10, v78
    v_accvgpr_write_b32 a14, v79
    v_perm_b32 v132, v212, v196, s35
    v_perm_b32 v136, v212, v196, s36
    v_perm_b32 v140, v213, v197, s35
    v_perm_b32 v144, v213, v197, s36
    v_perm_b32 v148, v214, v198, s35
    v_perm_b32 v152, v214, v198, s36
    v_perm_b32 v156, v215, v199, s35
    v_perm_b32 v160, v215, v199, s36
    s_waitcnt vmcnt(4)
    buffer_load_dwordx4 v[172:175], v1, s[16:19], s66 offen offset:1024 nt
    global_load_dwordx4 v[68:71], v[6:7], off offset:1024
    v_accvgpr_write_b32 a3, v80
    v_accvgpr_write_b32 a7, v81
    v_accvgpr_write_b32 a11, v82
    v_accvgpr_write_b32 a15, v83
    v_perm_b32 v133, v216, v200, s35
    v_perm_b32 v137, v216, v200, s36
    v_perm_b32 v141, v217, v201, s35
    v_perm_b32 v145, v217, v201, s36
    v_perm_b32 v149, v218, v202, s35
    v_perm_b32 v153, v218, v202, s36
    v_perm_b32 v157, v219, v203, s35
    v_perm_b32 v161, v219, v203, s36
    s_waitcnt vmcnt(5)
    buffer_load_dwordx4 v[176:179], v1, s[16:19], s67 offen offset:1024 nt
    v_mfma_f32_16x16x32_bf16 v[36:39], v[100:103], a[0:3], 0
    v_mfma_f32_16x16x32_bf16 v[40:43], v[104:107], a[0:3], 0
    v_perm_b32 v134, v220, v204, s35
    v_perm_b32 v138, v220, v204, s36
    v_perm_b32 v142, v221, v205, s35
    v_perm_b32 v146, v221, v205, s36
    v_perm_b32 v150, v222, v206, s35
    v_perm_b32 v154, v222, v206, s36
    v_perm_b32 v158, v223, v207, s35
    v_perm_b32 v162, v223, v207, s36
    s_waitcnt vmcnt(5)
    buffer_load_dwordx4 v[180:183], v1, s[16:19], s64 offen offset:1280 nt
    v_mfma_f32_16x16x32_bf16 v[44:47], v[108:111], a[0:3], 0
    v_mfma_f32_16x16x32_bf16 v[48:51], v[112:115], a[0:3], 0
    v_perm_b32 v135, v224, v208, s35
    v_perm_b32 v139, v224, v208, s36
    v_perm_b32 v143, v225, v209, s35
    v_perm_b32 v147, v225, v209, s36
    v_perm_b32 v151, v226, v210, s35
    v_perm_b32 v155, v226, v210, s36
    v_perm_b32 v159, v227, v211, s35
    v_perm_b32 v163, v227, v211, s36
    s_waitcnt vmcnt(5)
    buffer_load_dwordx4 v[184:187], v1, s[16:19], s65 offen offset:1280 nt
    v_mfma_f32_16x16x32_bf16 v[52:55], v[116:119], a[0:3], 0
    v_mfma_f32_16x16x32_bf16 v[56:59], v[120:123], a[0:3], 0
    s_waitcnt vmcnt(5)
    buffer_load_dwordx4 v[188:191], v1, s[16:19], s66 offen offset:1280 nt
    global_load_dwordx4 v[72:75], v[6:7], off offset:1280
    v_mfma_f32_16x16x32_bf16 v[60:63], v[124:127], a[0:3], 0
    v_mfma_f32_16x16x32_bf16 v[64:67], v[128:131], a[0:3], 0
    s_waitcnt vmcnt(6)
    buffer_load_dwordx4 v[192:195], v1, s[16:19], s67 offen offset:1280 nt
    v_mfma_f32_16x16x32_bf16 v[36:39], v[132:135], a[4:7], v[36:39]
    v_mfma_f32_16x16x32_bf16 v[40:43], v[136:139], a[4:7], v[40:43]
    s_waitcnt vmcnt(5)
    buffer_load_dwordx4 v[196:199], v1, s[16:19], s64 offen offset:1536 nt
    v_mfma_f32_16x16x32_bf16 v[44:47], v[140:143], a[4:7], v[44:47]
    v_mfma_f32_16x16x32_bf16 v[48:51], v[144:147], a[4:7], v[48:51]
    s_waitcnt vmcnt(5)
    buffer_load_dwordx4 v[200:203], v1, s[16:19], s65 offen offset:1536 nt
    v_mfma_f32_16x16x32_bf16 v[52:55], v[148:151], a[4:7], v[52:55]
    v_mfma_f32_16x16x32_bf16 v[56:59], v[152:155], a[4:7], v[56:59]
    v_accvgpr_write_b32 a16, v68
    v_accvgpr_write_b32 a20, v69
    v_accvgpr_write_b32 a24, v70
    v_accvgpr_write_b32 a28, v71
    v_perm_b32 v100, v180, v164, s35
    v_perm_b32 v104, v180, v164, s36
    v_perm_b32 v108, v181, v165, s35
    v_perm_b32 v112, v181, v165, s36
    v_perm_b32 v116, v182, v166, s35
    v_perm_b32 v120, v182, v166, s36
    v_perm_b32 v124, v183, v167, s35
    v_perm_b32 v128, v183, v167, s36
    s_waitcnt vmcnt(5)
    buffer_load_dwordx4 v[204:207], v1, s[16:19], s66 offen offset:1536 nt
    global_load_dwordx4 v[76:79], v[6:7], off offset:1536
    v_mfma_f32_16x16x32_bf16 v[60:63], v[156:159], a[4:7], v[60:63]
    v_mfma_f32_16x16x32_bf16 v[64:67], v[160:163], a[4:7], v[64:67]
    v_perm_b32 v101, v184, v168, s35
    v_perm_b32 v105, v184, v168, s36
    v_perm_b32 v109, v185, v169, s35
    v_perm_b32 v113, v185, v169, s36
    v_perm_b32 v117, v186, v170, s35
    v_perm_b32 v121, v186, v170, s36
    v_perm_b32 v125, v187, v171, s35
    v_perm_b32 v129, v187, v171, s36
    s_waitcnt vmcnt(6)
    buffer_load_dwordx4 v[208:211], v1, s[16:19], s67 offen offset:1536 nt
    v_perm_b32 v102, v188, v172, s35
    v_perm_b32 v106, v188, v172, s36
    v_perm_b32 v110, v189, v173, s35
    v_perm_b32 v114, v189, v173, s36
    v_perm_b32 v118, v190, v174, s35
    v_perm_b32 v122, v190, v174, s36
    v_perm_b32 v126, v191, v175, s35
    v_perm_b32 v130, v191, v175, s36
    s_waitcnt vmcnt(5)
    buffer_load_dwordx4 v[212:215], v1, s[16:19], s64 offen offset:1792 nt
    v_perm_b32 v103, v192, v176, s35
    v_perm_b32 v107, v192, v176, s36
    v_perm_b32 v111, v193, v177, s35
    v_perm_b32 v115, v193, v177, s36
    v_perm_b32 v119, v194, v178, s35
    v_perm_b32 v123, v194, v178, s36
    v_perm_b32 v127, v195, v179, s35
    v_perm_b32 v131, v195, v179, s36
    s_waitcnt vmcnt(5)
    buffer_load_dwordx4 v[216:219], v1, s[16:19], s65 offen offset:1792 nt
    v_mfma_f32_16x16x32_bf16 v[36:39], v[100:103], a[8:11], v[36:39]
    v_mfma_f32_16x16x32_bf16 v[40:43], v[104:107], a[8:11], v[40:43]
    v_accvgpr_write_b32 a17, v72
    v_accvgpr_write_b32 a21, v73
    v_accvgpr_write_b32 a25, v74
    v_accvgpr_write_b32 a29, v75
    s_cbranch_vccnz L_e25
    s_waitcnt vmcnt(5)
L_e25:
    buffer_load_dwordx4 v[220:223], v1, s[16:19], s66 offen offset:1792 nt
    s_waitcnt vmcnt(6)
    global_load_dwordx4 v[80:83], v[6:7], off offset:1792
    v_mfma_f32_16x16x32_bf16 v[44:47], v[108:111], a[8:11], v[44:47]
    v_mfma_f32_16x16x32_bf16 v[48:51], v[112:115], a[8:11], v[48:51]
    s_waitcnt vmcnt(6)
    buffer_load_dwordx4 v[224:227], v1, s[16:19], s67 offen offset:1792 nt
    v_mfma_f32_16x16x32_bf16 v[52:55], v[116:119], a[8:11], v[52:55]
    v_mfma_f32_16x16x32_bf16 v[56:59], v[120:123], a[8:11], v[56:59]
    s_waitcnt vmcnt(5)
    s_add_u32 s64, s33, 131072
    buffer_load_dwordx4 v[164:167], v1, s[16:19], s64 offen offset:0 nt
    v_mfma_f32_16x16x32_bf16 v[60:63], v[124:127], a[8:11], v[60:63]
    v_mfma_f32_16x16x32_bf16 v[64:67], v[128:131], a[8:11], v[64:67]
    s_waitcnt vmcnt(5)
    s_add_u32 s65, s33, 163840
    buffer_load_dwordx4 v[168:171], v1, s[16:19], s65 offen offset:0 nt
    v_accvgpr_write_b32 a18, v76
    v_accvgpr_write_b32 a22, v77
    v_accvgpr_write_b32 a26, v78
    v_accvgpr_write_b32 a30, v79
    v_perm_b32 v132, v212, v196, s35
    v_perm_b32 v136, v212, v196, s36
    v_perm_b32 v140, v213, v197, s35
    v_perm_b32 v144, v213, v197, s36
    v_perm_b32 v148, v214, v198, s35
    v_perm_b32 v152, v214, v198, s36
    v_perm_b32 v156, v215, v199, s35
    v_perm_b32 v160, v215, v199, s36
    s_waitcnt vmcnt(5)
    s_add_u32 s66, s33, 196608
    buffer_load_dwordx4 v[172:175], v1, s[16:19], s66 offen offset:0 nt
    v_perm_b32 v133, v216, v200, s35
    v_perm_b32 v137, v216, v200, s36
    v_perm_b32 v141, v217, v201, s35
    v_perm_b32 v145, v217, v201, s36
    v_perm_b32 v149, v218, v202, s35
    v_perm_b32 v153, v218, v202, s36
    v_perm_b32 v157, v219, v203, s35
    v_perm_b32 v161, v219, v203, s36
    s_waitcnt vmcnt(5)
    s_add_u32 s67, s33, 229376
    buffer_load_dwordx4 v[176:179], v1, s[16:19], s67 offen offset:0 nt
    v_perm_b32 v134, v220, v204, s35
    v_perm_b32 v138, v220, v204, s36
    v_perm_b32 v142, v221, v205, s35
    v_perm_b32 v146, v221, v205, s36
    v_perm_b32 v150, v222, v206, s35
    v_perm_b32 v154, v222, v206, s36
    v_perm_b32 v158, v223, v207, s35
    v_perm_b32 v162, v223, v207, s36
    s_waitcnt vmcnt(4)
    buffer_load_dwordx4 v[180:183], v1, s[16:19], s64 offen offset:256 nt
    v_perm_b32 v135, v224, v208, s35
    v_perm_b32 v139, v224, v208, s36
    v_perm_b32 v143, v225, v209, s35
    v_perm_b32 v147, v225, v209, s36
    v_perm_b32 v151, v226, v210, s35
    v_perm_b32 v155, v226, v210, s36
    v_perm_b32 v159, v227, v211, s35
    v_perm_b32 v163, v227, v211, s36
    s_waitcnt vmcnt(4)
    buffer_load_dwordx4 v[184:187], v1, s[16:19], s65 offen offset:256 nt
    v_mfma_f32_16x16x32_bf16 v[36:39], v[132:135], a[12:15], v[36:39]
    v_mfma_f32_16x16x32_bf16 v[40:43], v[136:139], a[12:15], v[40:43]
    v_accvgpr_write_b32 a19, v80
    v_accvgpr_write_b32 a23, v81
    v_accvgpr_write_b32 a27, v82
    v_accvgpr_write_b32 a31, v83
    s_waitcnt vmcnt(4)
    buffer_load_dwordx4 v[188:191], v1, s[16:19], s66 offen offset:256 nt
    v_mfma_f32_16x16x32_bf16 v[44:47], v[140:143], a[12:15], v[44:47]
    v_mfma_f32_16x16x32_bf16 v[48:51], v[144:147], a[12:15], v[48:51]
    s_waitcnt vmcnt(4)
    buffer_load_dwordx4 v[192:195], v1, s[16:19], s67 offen offset:256 nt
    global_load_dwordx4 v[68:71], v[6:7], off offset:2048
    v_mfma_f32_16x16x32_bf16 v[52:55], v[148:151], a[12:15], v[52:55]
    v_mfma_f32_16x16x32_bf16 v[56:59], v[152:155], a[12:15], v[56:59]
    s_waitcnt vmcnt(5)
    buffer_load_dwordx4 v[196:199], v1, s[16:19], s64 offen offset:512 nt
    v_mfma_f32_16x16x32_bf16 v[60:63], v[156:159], a[12:15], v[60:63]
    v_mfma_f32_16x16x32_bf16 v[64:67], v[160:163], a[12:15], v[64:67]
    s_waitcnt vmcnt(5)
    buffer_load_dwordx4 v[200:203], v1, s[16:19], s65 offen offset:512 nt
    v_perm_b32 v100, v180, v164, s35
    v_perm_b32 v104, v180, v164, s36
    v_perm_b32 v108, v181, v165, s35
    v_perm_b32 v112, v181, v165, s36
    v_perm_b32 v116, v182, v166, s35
    v_perm_b32 v120, v182, v166, s36
    v_perm_b32 v124, v183, v167, s35
    v_perm_b32 v128, v183, v167, s36
    s_waitcnt vmcnt(5)
    buffer_load_dwordx4 v[204:207], v1, s[16:19], s66 offen offset:512 nt
    v_perm_b32 v101, v184, v168, s35
    v_perm_b32 v105, v184, v168, s36
    v_perm_b32 v109, v185, v169, s35
    v_perm_b32 v113, v185, v169, s36
    v_perm_b32 v117, v186, v170, s35
    v_perm_b32 v121, v186, v170, s36
    v_perm_b32 v125, v187, v171, s35
    v_perm_b32 v129, v187, v171, s36
    s_waitcnt vmcnt(5)
    buffer_load_dwordx4 v[208:211], v1, s[16:19], s67 offen offset:512 nt
    v_perm_b32 v102, v188, v172, s35
    v_perm_b32 v106, v188, v172, s36
    v_perm_b32 v110, v189, v173, s35
    v_perm_b32 v114, v189, v173, s36
    v_perm_b32 v118, v190, v174, s35
    v_perm_b32 v122, v190, v174, s36
    v_perm_b32 v126, v191, v175, s35
    v_perm_b32 v130, v191, v175, s36
    s_waitcnt vmcnt(5)
    buffer_load_dwordx4 v[212:215], v1, s[16:19], s64 offen offset:768 nt
    v_perm_b32 v103, v192, v176, s35
    v_perm_b32 v107, v192, v176, s36
    v_perm_b32 v111, v193, v177, s35
    v_perm_b32 v115, v193, v177, s36
    v_perm_b32 v119, v194, v178, s35
    v_perm_b32 v123, v194, v178, s36
    v_perm_b32 v127, v195, v179, s35
    v_perm_b32 v131, v195, v179, s36
    s_waitcnt vmcnt(4)
    buffer_load_dwordx4 v[216:219], v1, s[16:19], s65 offen offset:768 nt
    buffer_load_dwordx4 v[20:23], v5, s[24:27], 0 offen offset:0
    buffer_load_dwordx4 v[24:27], v5, s[24:27], 0 offen offset:16
    buffer_load_dwordx4 v[28:31], v5, s[24:27], 0 offen offset:32
    buffer_load_dwordx4 v[32:35], v5, s[24:27], 0 offen offset:48
    v_mfma_f32_16x16x32_bf16 v[36:39], v[100:103], a[16:19], v[36:39]
    v_mfma_f32_16x16x32_bf16 v[40:43], v[104:107], a[16:19], v[40:43]
    s_cbranch_vccnz L_e41
    s_waitcnt vmcnt(8)
L_e41:
    buffer_load_dwordx4 v[220:223], v1, s[16:19], s66 offen offset:768 nt
    s_waitcnt vmcnt(9)
    v_mfma_f32_16x16x32_bf16 v[44:47], v[108:111], a[16:19], v[44:47]
    v_mfma_f32_16x16x32_bf16 v[48:51], v[112:115], a[16:19], v[48:51]
    v_accvgpr_write_b32 a32, v68
    v_accvgpr_write_b32 a36, v69
    v_accvgpr_write_b32 a40, v70
    v_accvgpr_write_b32 a44, v71
    s_waitcnt vmcnt(8)
    buffer_load_dwordx4 v[224:227], v1, s[16:19], s67 offen offset:768 nt
    global_load_dwordx4 v[72:75], v[6:7], off offset:2304
    v_mfma_f32_16x16x32_bf16 v[52:55], v[116:119], a[16:19], v[52:55]
    v_mfma_f32_16x16x32_bf16 v[56:59], v[120:123], a[16:19], v[56:59]
    s_waitcnt vmcnt(9)
    buffer_load_dwordx4 v[164:167], v1, s[16:19], s64 offen offset:1024 nt
    v_mfma_f32_16x16x32_bf16 v[60:63], v[124:127], a[16:19], v[60:63]
    v_mfma_f32_16x16x32_bf16 v[64:67], v[128:131], a[16:19], v[64:67]
    s_waitcnt vmcnt(9)
    buffer_load_dwordx4 v[168:171], v1, s[16:19], s65 offen offset:1024 nt
    v_perm_b32 v132, v212, v196, s35
    v_perm_b32 v136, v212, v196, s36
    v_perm_b32 v140, v213, v197, s35
    v_perm_b32 v144, v213, v197, s36
    v_perm_b32 v148, v214, v198, s35
    v_perm_b32 v152, v214, v198, s36
    v_perm_b32 v156, v215, v199, s35
    v_perm_b32 v160, v215, v199, s36
    s_waitcnt vmcnt(9)
    buffer_load_dwordx4 v[172:175], v1, s[16:19], s66 offen offset:1024 nt
    v_perm_b32 v133, v216, v200, s35
    v_perm_b32 v137, v216, v200, s36
    v_perm_b32 v141, v217, v201, s35
    v_perm_b32 v145, v217, v201, s36
    v_perm_b32 v149, v218, v202, s35
    v_perm_b32 v153, v218, v202, s36
    v_perm_b32 v157, v219, v203, s35
    v_perm_b32 v161, v219, v203, s36
    s_waitcnt vmcnt(5)
    buffer_load_dwordx4 v[176:179], v1, s[16:19], s67 offen offset:1024 nt
    v_perm_b32 v134, v220, v204, s35
    v_perm_b32 v138, v220, v204, s36
    v_perm_b32 v142, v221, v205, s35
    v_perm_b32 v146, v221, v205, s36
    v_perm_b32 v150, v222, v206, s35
    v_perm_b32 v154, v222, v206, s36
    v_perm_b32 v158, v223, v207, s35
    v_perm_b32 v162, v223, v207, s36
    s_waitcnt vmcnt(5)
    buffer_load_dwordx4 v[180:183], v1, s[16:19], s64 offen offset:1280 nt
    v_perm_b32 v135, v224, v208, s35
    v_perm_b32 v139, v224, v208, s36
    v_perm_b32 v143, v225, v209, s35
    v_perm_b32 v147, v225, v209, s36
    v_perm_b32 v151, v226, v210, s35
    v_perm_b32 v155, v226, v210, s36
    v_perm_b32 v159, v227, v211, s35
    v_perm_b32 v163, v227, v211, s36
    s_waitcnt vmcnt(4)
    buffer_load_dwordx4 v[184:187], v1, s[16:19], s65 offen offset:1280 nt
    v_mfma_f32_16x16x32_bf16 v[36:39], v[132:135], a[20:23], v[36:39]
    v_mfma_f32_16x16x32_bf16 v[40:43], v[136:139], a[20:23], v[40:43]
    s_waitcnt vmcnt(4)
    buffer_load_dwordx4 v[188:191], v1, s[16:19], s66 offen offset:1280 nt
    v_mfma_f32_16x16x32_bf16 v[44:47], v[140:143], a[20:23], v[44:47]
    v_mfma_f32_16x16x32_bf16 v[48:51], v[144:147], a[20:23], v[48:51]
    v_accvgpr_write_b32 a33, v72
    v_accvgpr_write_b32 a37, v73
    v_accvgpr_write_b32 a41, v74
    v_accvgpr_write_b32 a45, v75
    s_waitcnt vmcnt(4)
    buffer_load_dwordx4 v[192:195], v1, s[16:19], s67 offen offset:1280 nt
    global_load_dwordx4 v[76:79], v[6:7], off offset:2560
    v_mfma_f32_16x16x32_bf16 v[52:55], v[148:151], a[20:23], v[52:55]
    v_mfma_f32_16x16x32_bf16 v[56:59], v[152:155], a[20:23], v[56:59]
    s_waitcnt vmcnt(5)
    buffer_load_dwordx4 v[196:199], v1, s[16:19], s64 offen offset:1536 nt
    v_mfma_f32_16x16x32_bf16 v[60:63], v[156:159], a[20:23], v[60:63]
    v_mfma_f32_16x16x32_bf16 v[64:67], v[160:163], a[20:23], v[64:67]
    s_waitcnt vmcnt(5)
    buffer_load_dwordx4 v[200:203], v1, s[16:19], s65 offen offset:1536 nt
    v_perm_b32 v100, v180, v164, s35
    v_perm_b32 v104, v180, v164, s36
    v_perm_b32 v108, v181, v165, s35
    v_perm_b32 v112, v181, v165, s36
    v_perm_b32 v116, v182, v166, s35
    v_perm_b32 v120, v182, v166, s36
    v_perm_b32 v124, v183, v167, s35
    v_perm_b32 v128, v183, v167, s36
    s_waitcnt vmcnt(5)
    buffer_load_dwordx4 v[204:207], v1, s[16:19], s66 offen offset:1536 nt
    v_perm_b32 v101, v184, v168, s35
    v_perm_b32 v105, v184, v168, s36
    v_perm_b32 v109, v185, v169, s35
    v_perm_b32 v113, v185, v169, s36
    v_perm_b32 v117, v186, v170, s35
    v_perm_b32 v121, v186, v170, s36
    v_perm_b32 v125, v187, v171, s35
    v_perm_b32 v129, v187, v171, s36
    s_waitcnt vmcnt(5)
    buffer_load_dwordx4 v[208:211], v1, s[16:19], s67 offen offset:1536 nt
    v_perm_b32 v102, v188, v172, s35
    v_perm_b32 v106, v188, v172, s36
    v_perm_b32 v110, v189, v173, s35
    v_perm_b32 v114, v189, v173, s36
    v_perm_b32 v118, v190, v174, s35
    v_perm_b32 v122, v190, v174, s36
    v_perm_b32 v126, v191, v175, s35
    v_perm_b32 v130, v191, v175, s36
    s_waitcnt vmcnt(5)
    buffer_load_dwordx4 v[212:215], v1, s[16:19], s64 offen offset:1792 nt
    v_perm_b32 v103, v192, v176, s35
    v_perm_b32 v107, v192, v176, s36
    v_perm_b32 v111, v193, v177, s35
    v_perm_b32 v115, v193, v177, s36
    v_perm_b32 v119, v194, v178, s35
    v_perm_b32 v123, v194, v178, s36
    v_perm_b32 v127, v195, v179, s35
    v_perm_b32 v131, v195, v179, s36
    s_waitcnt vmcnt(4)
    buffer_load_dwordx4 v[216:219], v1, s[16:19], s65 offen offset:1792 nt
    v_mfma_f32_16x16x32_bf16 v[36:39], v[100:103], a[24:27], v[36:39]
    v_mfma_f32_16x16x32_bf16 v[40:43], v[104:107], a[24:27], v[40:43]
    s_cbranch_vccnz L_e57
    s_waitcnt vmcnt(4)
L_e57:
    buffer_load_dwordx4 v[220:223], v1, s[16:19], s66 offen offset:1792 nt
    s_waitcnt vmcnt(5)
    v_mfma_f32_16x16x32_bf16 v[44:47], v[108:111], a[24:27], v[44:47]
    v_mfma_f32_16x16x32_bf16 v[48:51], v[112:115], a[24:27], v[48:51]
    v_accvgpr_write_b32 a34, v76
    v_accvgpr_write_b32 a38, v77
    v_accvgpr_write_b32 a42, v78
    v_accvgpr_write_b32 a46, v79
    s_waitcnt vmcnt(4)
    buffer_load_dwordx4 v[224:227], v1, s[16:19], s67 offen offset:1792 nt
    global_load_dwordx4 v[80:83], v[6:7], off offset:2816
    v_mfma_f32_16x16x32_bf16 v[52:55], v[116:119], a[24:27], v[52:55]
    v_mfma_f32_16x16x32_bf16 v[56:59], v[120:123], a[24:27], v[56:59]
    s_waitcnt vmcnt(5)
    s_add_u32 s64, s33, 262144
    buffer_load_dwordx4 v[164:167], v1, s[16:19], s64 offen offset:0 nt
    v_mfma_f32_16x16x32_bf16 v[60:63], v[124:127], a[24:27], v[60:63]
    v_mfma_f32_16x16x32_bf16 v[64:67], v[128:131], a[24:27], v[64:67]
    s_waitcnt vmcnt(5)
    s_add_u32 s65, s33, 294912
    buffer_load_dwordx4 v[168:171], v1, s[16:19], s65 offen offset:0 nt
    v_perm_b32 v132, v212, v196, s35
    v_perm_b32 v136, v212, v196, s36
    v_perm_b32 v140, v213, v197, s35
    v_perm_b32 v144, v213, v197, s36
    v_perm_b32 v148, v214, v198, s35
    v_perm_b32 v152, v214, v198, s36
    v_perm_b32 v156, v215, v199, s35
    v_perm_b32 v160, v215, v199, s36
    s_waitcnt vmcnt(5)
    s_add_u32 s66, s33, 327680
    buffer_load_dwordx4 v[172:175], v1, s[16:19], s66 offen offset:0 nt
    v_perm_b32 v133, v216, v200, s35
    v_perm_b32 v137, v216, v200, s36
    v_perm_b32 v141, v217, v201, s35
    v_perm_b32 v145, v217, v201, s36
    v_perm_b32 v149, v218, v202, s35
    v_perm_b32 v153, v218, v202, s36
    v_perm_b32 v157, v219, v203, s35
    v_perm_b32 v161, v219, v203, s36
    s_waitcnt vmcnt(5)
    s_add_u32 s67, s33, 360448
    buffer_load_dwordx4 v[176:179], v1, s[16:19], s67 offen offset:0 nt
    v_perm_b32 v134, v220, v204, s35
    v_perm_b32 v138, v220, v204, s36
    v_perm_b32 v142, v221, v205, s35
    v_perm_b32 v146, v221, v205, s36
    v_perm_b32 v150, v222, v206, s35
    v_perm_b32 v154, v222, v206, s36
    v_perm_b32 v158, v223, v207, s35
    v_perm_b32 v162, v223, v207, s36
    s_waitcnt vmcnt(5)
    buffer_load_dwordx4 v[180:183], v1, s[16:19], s64 offen offset:256 nt
    v_perm_b32 v135, v224, v208, s35
    v_perm_b32 v139, v224, v208, s36
    v_perm_b32 v143, v225, v209, s35
    v_perm_b32 v147, v225, v209, s36
    v_perm_b32 v151, v226, v210, s35
    v_perm_b32 v155, v226, v210, s36
    v_perm_b32 v159, v227, v211, s35
    v_perm_b32 v163, v227, v211, s36
    s_waitcnt vmcnt(4)
    buffer_load_dwordx4 v[184:187], v1, s[16:19], s65 offen offset:256 nt
    v_mfma_f32_16x16x32_bf16 v[36:39], v[132:135], a[28:31], v[36:39]
    v_mfma_f32_16x16x32_bf16 v[40:43], v[136:139], a[28:31], v[40:43]
    s_waitcnt vmcnt(4)
    buffer_load_dwordx4 v[188:191], v1, s[16:19], s66 offen offset:256 nt
    v_mfma_f32_16x16x32_bf16 v[44:47], v[140:143], a[28:31], v[44:47]
    v_mfma_f32_16x16x32_bf16 v[48:51], v[144:147], a[28:31], v[48:51]
    v_accvgpr_write_b32 a35, v80
    v_accvgpr_write_b32 a39, v81
    v_accvgpr_write_b32 a43, v82
    v_accvgpr_write_b32 a47, v83
    s_waitcnt vmcnt(4)
    buffer_load_dwordx4 v[192:195], v1, s[16:19], s67 offen offset:256 nt
    global_load_dwordx4 v[68:71], v[6:7], off offset:3072
    v_mfma_f32_16x16x32_bf16 v[52:55], v[148:151], a[28:31], v[52:55]
    v_mfma_f32_16x16x32_bf16 v[56:59], v[152:155], a[28:31], v[56:59]
    s_waitcnt vmcnt(5)
    buffer_load_dwordx4 v[196:199], v1, s[16:19], s64 offen offset:512 nt
    v_mfma_f32_16x16x32_bf16 v[60:63], v[156:159], a[28:31], v[60:63]
    v_mfma_f32_16x16x32_bf16 v[64:67], v[160:163], a[28:31], v[64:67]
    s_waitcnt vmcnt(5)
    buffer_load_dwordx4 v[200:203], v1, s[16:19], s65 offen offset:512 nt
    v_perm_b32 v100, v180, v164, s35
    v_perm_b32 v104, v180, v164, s36
    v_perm_b32 v108, v181, v165, s35
    v_perm_b32 v112, v181, v165, s36
    v_perm_b32 v116, v182, v166, s35
    v_perm_b32 v120, v182, v166, s36
    v_perm_b32 v124, v183, v167, s35
    v_perm_b32 v128, v183, v167, s36
    s_waitcnt vmcnt(5)
    buffer_load_dwordx4 v[204:207], v1, s[16:19], s66 offen offset:512 nt
    v_perm_b32 v101, v184, v168, s35
    v_perm_b32 v105, v184, v168, s36
    v_perm_b32 v109, v185, v169, s35
    v_perm_b32 v113, v185, v169, s36
    v_perm_b32 v117, v186, v170, s35
    v_perm_b32 v121, v186, v170, s36
    v_perm_b32 v125, v187, v171, s35
    v_perm_b32 v129, v187, v171, s36
    s_waitcnt vmcnt(5)
    buffer_load_dwordx4 v[208:211], v1, s[16:19], s67 offen offset:512 nt
    v_perm_b32 v102, v188, v172, s35
    v_perm_b32 v106, v188, v172, s36
    v_perm_b32 v110, v189, v173, s35
    v_perm_b32 v114, v189, v173, s36
    v_perm_b32 v118, v190, v174, s35
    v_perm_b32 v122, v190, v174, s36
    v_perm_b32 v126, v191, v175, s35
    v_perm_b32 v130, v191, v175, s36
    s_waitcnt vmcnt(5)
    buffer_load_dwordx4 v[212:215], v1, s[16:19], s64 offen offset:768 nt
    v_perm_b32 v103, v192, v176, s35
    v_perm_b32 v107, v192, v176, s36
    v_perm_b32 v111, v193, v177, s35
    v_perm_b32 v115, v193, v177, s36
    v_perm_b32 v119, v194, v178, s35
    v_perm_b32 v123, v194, v178, s36
    v_perm_b32 v127, v195, v179, s35
    v_perm_b32 v131, v195, v179, s36
    s_waitcnt vmcnt(4)
    buffer_load_dwordx4 v[216:219], v1, s[16:19], s65 offen offset:768 nt
    v_mfma_f32_16x16x32_bf16 v[36:39], v[100:103], a[32:35], v[36:39]
    v_mfma_f32_16x16x32_bf16 v[40:43], v[104:107], a[32:35], v[40:43]
    s_cbranch_vccnz L_e73
    s_waitcnt vmcnt(4)
L_e73:
    buffer_load_dwordx4 v[220:223], v1, s[16:19], s66 offen offset:768 nt
    s_waitcnt vmcnt(5)
    v_mfma_f32_16x16x32_bf16 v[44:47], v[108:111], a[32:35], v[44:47]
    v_mfma_f32_16x16x32_bf16 v[48:51], v[112:115], a[32:35], v[48:51]
    v_accvgpr_write_b32 a48, v68
    v_accvgpr_write_b32 a52, v69
    v_accvgpr_write_b32 a56, v70
    v_accvgpr_write_b32 a60, v71
    s_waitcnt vmcnt(4)
    buffer_load_dwordx4 v[224:227], v1, s[16:19], s67 offen offset:768 nt
    global_load_dwordx4 v[72:75], v[6:7], off offset:3328
    v_mfma_f32_16x16x32_bf16 v[52:55], v[116:119], a[32:35], v[52:55]
    v_mfma_f32_16x16x32_bf16 v[56:59], v[120:123], a[32:35], v[56:59]
    s_waitcnt vmcnt(5)
    buffer_load_dwordx4 v[164:167], v1, s[16:19], s64 offen offset:1024 nt
    v_mfma_f32_16x16x32_bf16 v[60:63], v[124:127], a[32:35], v[60:63]
    v_mfma_f32_16x16x32_bf16 v[64:67], v[128:131], a[32:35], v[64:67]
    s_waitcnt vmcnt(5)
    buffer_load_dwordx4 v[168:171], v1, s[16:19], s65 offen offset:1024 nt
    v_perm_b32 v132, v212, v196, s35
    v_perm_b32 v136, v212, v196, s36
    v_perm_b32 v140, v213, v197, s35
    v_perm_b32 v144, v213, v197, s36
    v_perm_b32 v148, v214, v198, s35
    v_perm_b32 v152, v214, v198, s36
    v_perm_b32 v156, v215, v199, s35
    v_perm_b32 v160, v215, v199, s36
    s_waitcnt vmcnt(5)
    buffer_load_dwordx4 v[172:175], v1, s[16:19], s66 offen offset:1024 nt
    v_perm_b32 v133, v216, v200, s35
    v_perm_b32 v137, v216, v200, s36
    v_perm_b32 v141, v217, v201, s35
    v_perm_b32 v145, v217, v201, s36
    v_perm_b32 v149, v218, v202, s35
    v_perm_b32 v153, v218, v202, s36
    v_perm_b32 v157, v219, v203, s35
    v_perm_b32 v161, v219, v203, s36
    s_waitcnt vmcnt(5)
    buffer_load_dwordx4 v[176:179], v1, s[16:19], s67 offen offset:1024 nt
    v_perm_b32 v134, v220, v204, s35
    v_perm_b32 v138, v220, v204, s36
    v_perm_b32 v142, v221, v205, s35
    v_perm_b32 v146, v221, v205, s36
    v_perm_b32 v150, v222, v206, s35
    v_perm_b32 v154, v222, v206, s36
    v_perm_b32 v158, v223, v207, s35
    v_perm_b32 v162, v223, v207, s36
    s_waitcnt vmcnt(5)
    buffer_load_dwordx4 v[180:183], v1, s[16:19], s64 offen offset:1280 nt
    v_perm_b32 v135, v224, v208, s35
    v_perm_b32 v139, v224, v208, s36
    v_perm_b32 v143, v225, v209, s35
    v_perm_b32 v147, v225, v209, s36
    v_perm_b32 v151, v226, v210, s35
    v_perm_b32 v155, v226, v210, s36
    v_perm_b32 v159, v227, v211, s35
    v_perm_b32 v163, v227, v211, s36
    s_waitcnt vmcnt(4)
    buffer_load_dwordx4 v[184:187], v1, s[16:19], s65 offen offset:1280 nt
    v_mfma_f32_16x16x32_bf16 v[36:39], v[132:135], a[36:39], v[36:39]
    v_mfma_f32_16x16x32_bf16 v[40:43], v[136:139], a[36:39], v[40:43]
    s_waitcnt vmcnt(4)
    buffer_load_dwordx4 v[188:191], v1, s[16:19], s66 offen offset:1280 nt
    v_mfma_f32_16x16x32_bf16 v[44:47], v[140:143], a[36:39], v[44:47]
    v_mfma_f32_16x16x32_bf16 v[48:51], v[144:147], a[36:39], v[48:51]
    v_accvgpr_write_b32 a49, v72
    v_accvgpr_write_b32 a53, v73
    v_accvgpr_write_b32 a57, v74
    v_accvgpr_write_b32 a61, v75
    s_waitcnt vmcnt(4)
    buffer_load_dwordx4 v[192:195], v1, s[16:19], s67 offen offset:1280 nt
    global_load_dwordx4 v[76:79], v[6:7], off offset:3584
    v_mfma_f32_16x16x32_bf16 v[52:55], v[148:151], a[36:39], v[52:55]
    v_mfma_f32_16x16x32_bf16 v[56:59], v[152:155], a[36:39], v[56:59]
    s_waitcnt vmcnt(5)
    buffer_load_dwordx4 v[196:199], v1, s[16:19], s64 offen offset:1536 nt
    v_mfma_f32_16x16x32_bf16 v[60:63], v[156:159], a[36:39], v[60:63]
    v_mfma_f32_16x16x32_bf16 v[64:67], v[160:163], a[36:39], v[64:67]
    s_waitcnt vmcnt(5)
    buffer_load_dwordx4 v[200:203], v1, s[16:19], s65 offen offset:1536 nt
    v_perm_b32 v100, v180, v164, s35
    v_perm_b32 v104, v180, v164, s36
    v_perm_b32 v108, v181, v165, s35
    v_perm_b32 v112, v181, v165, s36
    v_perm_b32 v116, v182, v166, s35
    v_perm_b32 v120, v182, v166, s36
    v_perm_b32 v124, v183, v167, s35
    v_perm_b32 v128, v183, v167, s36
    s_waitcnt vmcnt(5)
    buffer_load_dwordx4 v[204:207], v1, s[16:19], s66 offen offset:1536 nt
    v_perm_b32 v101, v184, v168, s35
    v_perm_b32 v105, v184, v168, s36
    v_perm_b32 v109, v185, v169, s35
    v_perm_b32 v113, v185, v169, s36
    v_perm_b32 v117, v186, v170, s35
    v_perm_b32 v121, v186, v170, s36
    v_perm_b32 v125, v187, v171, s35
    v_perm_b32 v129, v187, v171, s36
    s_waitcnt vmcnt(5)
    buffer_load_dwordx4 v[208:211], v1, s[16:19], s67 offen offset:1536 nt
    v_perm_b32 v102, v188, v172, s35
    v_perm_b32 v106, v188, v172, s36
    v_perm_b32 v110, v189, v173, s35
    v_perm_b32 v114, v189, v173, s36
    v_perm_b32 v118, v190, v174, s35
    v_perm_b32 v122, v190, v174, s36
    v_perm_b32 v126, v191, v175, s35
    v_perm_b32 v130, v191, v175, s36
    s_waitcnt vmcnt(5)
    buffer_load_dwordx4 v[212:215], v1, s[16:19], s64 offen offset:1792 nt
    v_perm_b32 v103, v192, v176, s35
    v_perm_b32 v107, v192, v176, s36
    v_perm_b32 v111, v193, v177, s35
    v_perm_b32 v115, v193, v177, s36
    v_perm_b32 v119, v194, v178, s35
    v_perm_b32 v123, v194, v178, s36
    v_perm_b32 v127, v195, v179, s35
    v_perm_b32 v131, v195, v179, s36
    s_waitcnt vmcnt(4)
    buffer_load_dwordx4 v[216:219], v1, s[16:19], s65 offen offset:1792 nt
    v_mfma_f32_16x16x32_bf16 v[36:39], v[100:103], a[40:43], v[36:39]
    v_mfma_f32_16x16x32_bf16 v[40:43], v[104:107], a[40:43], v[40:43]
    s_cbranch_vccnz L_e89
    s_waitcnt vmcnt(4)
L_e89:
    buffer_load_dwordx4 v[220:223], v1, s[16:19], s66 offen offset:1792 nt
    s_waitcnt vmcnt(5)
    v_mfma_f32_16x16x32_bf16 v[44:47], v[108:111], a[40:43], v[44:47]
    v_mfma_f32_16x16x32_bf16 v[48:51], v[112:115], a[40:43], v[48:51]
    v_accvgpr_write_b32 a50, v76
    v_accvgpr_write_b32 a54, v77
    v_accvgpr_write_b32 a58, v78
    v_accvgpr_write_b32 a62, v79
    s_waitcnt vmcnt(4)
    buffer_load_dwordx4 v[224:227], v1, s[16:19], s67 offen offset:1792 nt
    global_load_dwordx4 v[80:83], v[6:7], off offset:3840
    v_mfma_f32_16x16x32_bf16 v[52:55], v[116:119], a[40:43], v[52:55]
    v_mfma_f32_16x16x32_bf16 v[56:59], v[120:123], a[40:43], v[56:59]
    s_waitcnt vmcnt(5)
    s_add_u32 s64, s33, 393216
    buffer_load_dwordx4 v[164:167], v1, s[16:19], s64 offen offset:0 nt
    v_mfma_f32_16x16x32_bf16 v[60:63], v[124:127], a[40:43], v[60:63]
    v_mfma_f32_16x16x32_bf16 v[64:67], v[128:131], a[40:43], v[64:67]
    s_waitcnt vmcnt(5)
    s_add_u32 s65, s33, 425984
    buffer_load_dwordx4 v[168:171], v1, s[16:19], s65 offen offset:0 nt
    v_perm_b32 v132, v212, v196, s35
    v_perm_b32 v136, v212, v196, s36
    v_perm_b32 v140, v213, v197, s35
    v_perm_b32 v144, v213, v197, s36
    v_perm_b32 v148, v214, v198, s35
    v_perm_b32 v152, v214, v198, s36
    v_perm_b32 v156, v215, v199, s35
    v_perm_b32 v160, v215, v199, s36
    s_waitcnt vmcnt(5)
    s_add_u32 s66, s33, 458752
    buffer_load_dwordx4 v[172:175], v1, s[16:19], s66 offen offset:0 nt
    v_perm_b32 v133, v216, v200, s35
    v_perm_b32 v137, v216, v200, s36
    v_perm_b32 v141, v217, v201, s35
    v_perm_b32 v145, v217, v201, s36
    v_perm_b32 v149, v218, v202, s35
    v_perm_b32 v153, v218, v202, s36
    v_perm_b32 v157, v219, v203, s35
    v_perm_b32 v161, v219, v203, s36
    s_waitcnt vmcnt(5)
    s_add_u32 s67, s33, 491520
    buffer_load_dwordx4 v[176:179], v1, s[16:19], s67 offen offset:0 nt
    v_perm_b32 v134, v220, v204, s35
    v_perm_b32 v138, v220, v204, s36
    v_perm_b32 v142, v221, v205, s35
    v_perm_b32 v146, v221, v205, s36
    v_perm_b32 v150, v222, v206, s35
    v_perm_b32 v154, v222, v206, s36
    v_perm_b32 v158, v223, v207, s35
    v_perm_b32 v162, v223, v207, s36
    s_waitcnt vmcnt(5)
    buffer_load_dwordx4 v[180:183], v1, s[16:19], s64 offen offset:256 nt
    v_perm_b32 v135, v224, v208, s35
    v_perm_b32 v139, v224, v208, s36
    v_perm_b32 v143, v225, v209, s35
    v_perm_b32 v147, v225, v209, s36
    v_perm_b32 v151, v226, v210, s35
    v_perm_b32 v155, v226, v210, s36
    v_perm_b32 v159, v227, v211, s35
    v_perm_b32 v163, v227, v211, s36
    s_waitcnt vmcnt(4)
    buffer_load_dwordx4 v[184:187], v1, s[16:19], s65 offen offset:256 nt
    v_mfma_f32_16x16x32_bf16 v[36:39], v[132:135], a[44:47], v[36:39]
    v_mfma_f32_16x16x32_bf16 v[40:43], v[136:139], a[44:47], v[40:43]
    s_waitcnt vmcnt(4)
    buffer_load_dwordx4 v[188:191], v1, s[16:19], s66 offen offset:256 nt
    v_mfma_f32_16x16x32_bf16 v[44:47], v[140:143], a[44:47], v[44:47]
    v_mfma_f32_16x16x32_bf16 v[48:51], v[144:147], a[44:47], v[48:51]
    v_accvgpr_write_b32 a51, v80
    v_accvgpr_write_b32 a55, v81
    v_accvgpr_write_b32 a59, v82
    v_accvgpr_write_b32 a63, v83
    s_waitcnt vmcnt(4)
    buffer_load_dwordx4 v[192:195], v1, s[16:19], s67 offen offset:256 nt
    v_mfma_f32_16x16x32_bf16 v[52:55], v[148:151], a[44:47], v[52:55]
    v_mfma_f32_16x16x32_bf16 v[56:59], v[152:155], a[44:47], v[56:59]
    s_waitcnt vmcnt(4)
    buffer_load_dwordx4 v[196:199], v1, s[16:19], s64 offen offset:512 nt
    v_mfma_f32_16x16x32_bf16 v[60:63], v[156:159], a[44:47], v[60:63]
    v_mfma_f32_16x16x32_bf16 v[64:67], v[160:163], a[44:47], v[64:67]
    s_waitcnt vmcnt(4)
    buffer_load_dwordx4 v[200:203], v1, s[16:19], s65 offen offset:512 nt
    v_perm_b32 v100, v180, v164, s35
    v_perm_b32 v104, v180, v164, s36
    v_perm_b32 v108, v181, v165, s35
    v_perm_b32 v112, v181, v165, s36
    v_perm_b32 v116, v182, v166, s35
    v_perm_b32 v120, v182, v166, s36
    v_perm_b32 v124, v183, v167, s35
    v_perm_b32 v128, v183, v167, s36
    s_waitcnt vmcnt(4)
    buffer_load_dwordx4 v[204:207], v1, s[16:19], s66 offen offset:512 nt
    v_perm_b32 v101, v184, v168, s35
    v_perm_b32 v105, v184, v168, s36
    v_perm_b32 v109, v185, v169, s35
    v_perm_b32 v113, v185, v169, s36
    v_perm_b32 v117, v186, v170, s35
    v_perm_b32 v121, v186, v170, s36
    v_perm_b32 v125, v187, v171, s35
    v_perm_b32 v129, v187, v171, s36
    s_waitcnt vmcnt(4)
    buffer_load_dwordx4 v[208:211], v1, s[16:19], s67 offen offset:512 nt
    v_perm_b32 v102, v188, v172, s35
    v_perm_b32 v106, v188, v172, s36
    v_perm_b32 v110, v189, v173, s35
    v_perm_b32 v114, v189, v173, s36
    v_perm_b32 v118, v190, v174, s35
    v_perm_b32 v122, v190, v174, s36
    v_perm_b32 v126, v191, v175, s35
    v_perm_b32 v130, v191, v175, s36
    s_waitcnt vmcnt(4)
    buffer_load_dwordx4 v[212:215], v1, s[16:19], s64 offen offset:768 nt
    v_perm_b32 v103, v192, v176, s35
    v_perm_b32 v107, v192, v176, s36
    v_perm_b32 v111, v193, v177, s35
    v_perm_b32 v115, v193, v177, s36
    v_perm_b32 v119, v194, v178, s35
    v_perm_b32 v123, v194, v178, s36
    v_perm_b32 v127, v195, v179, s35
    v_perm_b32 v131, v195, v179, s36
    s_waitcnt vmcnt(4)
    buffer_load_dwordx4 v[216:219], v1, s[16:19], s65 offen offset:768 nt
    v_mfma_f32_16x16x32_bf16 v[36:39], v[100:103], a[48:51], v[36:39]
    v_mfma_f32_16x16x32_bf16 v[40:43], v[104:107], a[48:51], v[40:43]
    s_cbranch_vccnz L_e105
    s_waitcnt vmcnt(4)
L_e105:
    buffer_load_dwordx4 v[220:223], v1, s[16:19], s66 offen offset:768 nt
    s_waitcnt vmcnt(5)
    v_mfma_f32_16x16x32_bf16 v[44:47], v[108:111], a[48:51], v[44:47]
    v_mfma_f32_16x16x32_bf16 v[48:51], v[112:115], a[48:51], v[48:51]
    s_waitcnt vmcnt(4)
    buffer_load_dwordx4 v[224:227], v1, s[16:19], s67 offen offset:768 nt
    v_mfma_f32_16x16x32_bf16 v[52:55], v[116:119], a[48:51], v[52:55]
    v_mfma_f32_16x16x32_bf16 v[56:59], v[120:123], a[48:51], v[56:59]
    s_waitcnt vmcnt(4)
    buffer_load_dwordx4 v[164:167], v1, s[16:19], s64 offen offset:1024 nt
    v_mfma_f32_16x16x32_bf16 v[60:63], v[124:127], a[48:51], v[60:63]
    v_mfma_f32_16x16x32_bf16 v[64:67], v[128:131], a[48:51], v[64:67]
    s_waitcnt vmcnt(4)
    buffer_load_dwordx4 v[168:171], v1, s[16:19], s65 offen offset:1024 nt
    v_perm_b32 v132, v212, v196, s35
    v_perm_b32 v136, v212, v196, s36
    v_perm_b32 v140, v213, v197, s35
    v_perm_b32 v144, v213, v197, s36
    v_perm_b32 v148, v214, v198, s35
    v_perm_b32 v152, v214, v198, s36
    v_perm_b32 v156, v215, v199, s35
    v_perm_b32 v160, v215, v199, s36
    s_waitcnt vmcnt(4)
    buffer_load_dwordx4 v[172:175], v1, s[16:19], s66 offen offset:1024 nt
    v_perm_b32 v133, v216, v200, s35
    v_perm_b32 v137, v216, v200, s36
    v_perm_b32 v141, v217, v201, s35
    v_perm_b32 v145, v217, v201, s36
    v_perm_b32 v149, v218, v202, s35
    v_perm_b32 v153, v218, v202, s36
    v_perm_b32 v157, v219, v203, s35
    v_perm_b32 v161, v219, v203, s36
    s_waitcnt vmcnt(4)
    buffer_load_dwordx4 v[176:179], v1, s[16:19], s67 offen offset:1024 nt
    v_perm_b32 v134, v220, v204, s35
    v_perm_b32 v138, v220, v204, s36
    v_perm_b32 v142, v221, v205, s35
    v_perm_b32 v146, v221, v205, s36
    v_perm_b32 v150, v222, v206, s35
    v_perm_b32 v154, v222, v206, s36
    v_perm_b32 v158, v223, v207, s35
    v_perm_b32 v162, v223, v207, s36
    s_waitcnt vmcnt(4)
    buffer_load_dwordx4 v[180:183], v1, s[16:19], s64 offen offset:1280 nt
    v_perm_b32 v135, v224, v208, s35
    v_perm_b32 v139, v224, v208, s36
    v_perm_b32 v143, v225, v209, s35
    v_perm_b32 v147, v225, v209, s36
    v_perm_b32 v151, v226, v210, s35
    v_perm_b32 v155, v226, v210, s36
    v_perm_b32 v159, v227, v211, s35
    v_perm_b32 v163, v227, v211, s36
    s_waitcnt vmcnt(4)
    buffer_load_dwordx4 v[184:187], v1, s[16:19], s65 offen offset:1280 nt
    v_mfma_f32_16x16x32_bf16 v[36:39], v[132:135], a[52:55], v[36:39]
    v_mfma_f32_16x16x32_bf16 v[40:43], v[136:139], a[52:55], v[40:43]
    s_waitcnt vmcnt(4)
    buffer_load_dwordx4 v[188:191], v1, s[16:19], s66 offen offset:1280 nt
    v_mfma_f32_16x16x32_bf16 v[44:47], v[140:143], a[52:55], v[44:47]
    v_mfma_f32_16x16x32_bf16 v[48:51], v[144:147], a[52:55], v[48:51]
    s_waitcnt vmcnt(4)
    buffer_load_dwordx4 v[192:195], v1, s[16:19], s67 offen offset:1280 nt
    v_mfma_f32_16x16x32_bf16 v[52:55], v[148:151], a[52:55], v[52:55]
    v_mfma_f32_16x16x32_bf16 v[56:59], v[152:155], a[52:55], v[56:59]
    s_waitcnt vmcnt(4)
    buffer_load_dwordx4 v[196:199], v1, s[16:19], s64 offen offset:1536 nt
    v_mfma_f32_16x16x32_bf16 v[60:63], v[156:159], a[52:55], v[60:63]
    v_mfma_f32_16x16x32_bf16 v[64:67], v[160:163], a[52:55], v[64:67]
    s_waitcnt vmcnt(4)
    buffer_load_dwordx4 v[200:203], v1, s[16:19], s65 offen offset:1536 nt
    v_perm_b32 v100, v180, v164, s35
    v_perm_b32 v104, v180, v164, s36
    v_perm_b32 v108, v181, v165, s35
    v_perm_b32 v112, v181, v165, s36
    v_perm_b32 v116, v182, v166, s35
    v_perm_b32 v120, v182, v166, s36
    v_perm_b32 v124, v183, v167, s35
    v_perm_b32 v128, v183, v167, s36
    s_waitcnt vmcnt(4)
    buffer_load_dwordx4 v[204:207], v1, s[16:19], s66 offen offset:1536 nt
    v_perm_b32 v101, v184, v168, s35
    v_perm_b32 v105, v184, v168, s36
    v_perm_b32 v109, v185, v169, s35
    v_perm_b32 v113, v185, v169, s36
    v_perm_b32 v117, v186, v170, s35
    v_perm_b32 v121, v186, v170, s36
    v_perm_b32 v125, v187, v171, s35
    v_perm_b32 v129, v187, v171, s36
    s_waitcnt vmcnt(4)
    buffer_load_dwordx4 v[208:211], v1, s[16:19], s67 offen offset:1536 nt
    v_perm_b32 v102, v188, v172, s35
    v_perm_b32 v106, v188, v172, s36
    v_perm_b32 v110, v189, v173, s35
    v_perm_b32 v114, v189, v173, s36
    v_perm_b32 v118, v190, v174, s35
    v_perm_b32 v122, v190, v174, s36
    v_perm_b32 v126, v191, v175, s35
    v_perm_b32 v130, v191, v175, s36
    s_waitcnt vmcnt(4)
    buffer_load_dwordx4 v[212:215], v1, s[16:19], s64 offen offset:1792 nt
    v_perm_b32 v103, v192, v176, s35
    v_perm_b32 v107, v192, v176, s36
    v_perm_b32 v111, v193, v177, s35
    v_perm_b32 v115, v193, v177, s36
    v_perm_b32 v119, v194, v178, s35
    v_perm_b32 v123, v194, v178, s36
    v_perm_b32 v127, v195, v179, s35
    v_perm_b32 v131, v195, v179, s36
    s_waitcnt vmcnt(4)
    buffer_load_dwordx4 v[216:219], v1, s[16:19], s65 offen offset:1792 nt
    v_mfma_f32_16x16x32_bf16 v[36:39], v[100:103], a[56:59], v[36:39]
    v_mfma_f32_16x16x32_bf16 v[40:43], v[104:107], a[56:59], v[40:43]
    s_cbranch_vccnz L_e121
    s_waitcnt vmcnt(4)
L_e121:
    buffer_load_dwordx4 v[220:223], v1, s[16:19], s66 offen offset:1792 nt
    s_waitcnt vmcnt(5)
    v_mfma_f32_16x16x32_bf16 v[44:47], v[108:111], a[56:59], v[44:47]
    v_mfma_f32_16x16x32_bf16 v[48:51], v[112:115], a[56:59], v[48:51]
    s_waitcnt vmcnt(4)
    buffer_load_dwordx4 v[224:227], v1, s[16:19], s67 offen offset:1792 nt
    v_mfma_f32_16x16x32_bf16 v[52:55], v[116:119], a[56:59], v[52:55]
    v_mfma_f32_16x16x32_bf16 v[56:59], v[120:123], a[56:59], v[56:59]
    s_waitcnt vmcnt(4)
    s_add_u32 s64, s33, 0
    buffer_load_dwordx4 v[164:167], v1, s[20:23], s64 offen offset:0 nt
    v_mfma_f32_16x16x32_bf16 v[60:63], v[124:127], a[56:59], v[60:63]
    v_mfma_f32_16x16x32_bf16 v[64:67], v[128:131], a[56:59], v[64:67]
    s_waitcnt vmcnt(4)
    s_add_u32 s65, s33, 32768
    buffer_load_dwordx4 v[168:171], v1, s[20:23], s65 offen offset:0 nt
    v_perm_b32 v132, v212, v196, s35
    v_perm_b32 v136, v212, v196, s36
    v_perm_b32 v140, v213, v197, s35
    v_perm_b32 v144, v213, v197, s36
    v_perm_b32 v148, v214, v198, s35
    v_perm_b32 v152, v214, v198, s36
    v_perm_b32 v156, v215, v199, s35
    v_perm_b32 v160, v215, v199, s36
    s_waitcnt vmcnt(4)
    s_add_u32 s66, s33, 65536
    buffer_load_dwordx4 v[172:175], v1, s[20:23], s66 offen offset:0 nt
    v_perm_b32 v133, v216, v200, s35
    v_perm_b32 v137, v216, v200, s36
    v_perm_b32 v141, v217, v201, s35
    v_perm_b32 v145, v217, v201, s36
    v_perm_b32 v149, v218, v202, s35
    v_perm_b32 v153, v218, v202, s36
    v_perm_b32 v157, v219, v203, s35
    v_perm_b32 v161, v219, v203, s36
    s_waitcnt vmcnt(4)
    s_add_u32 s67, s33, 98304
    buffer_load_dwordx4 v[176:179], v1, s[20:23], s67 offen offset:0 nt
    v_perm_b32 v134, v220, v204, s35
    v_perm_b32 v138, v220, v204, s36
    v_perm_b32 v142, v221, v205, s35
    v_perm_b32 v146, v221, v205, s36
    v_perm_b32 v150, v222, v206, s35
    v_perm_b32 v154, v222, v206, s36
    v_perm_b32 v158, v223, v207, s35
    v_perm_b32 v162, v223, v207, s36
    s_waitcnt vmcnt(4)
    buffer_load_dwordx4 v[180:183], v1, s[20:23], s64 offen offset:256 nt
    v_perm_b32 v135, v224, v208, s35
    v_perm_b32 v139, v224, v208, s36
    v_perm_b32 v143, v225, v209, s35
    v_perm_b32 v147, v225, v209, s36
    v_perm_b32 v151, v226, v210, s35
    v_perm_b32 v155, v226, v210, s36
    v_perm_b32 v159, v227, v211, s35
    v_perm_b32 v163, v227, v211, s36
    s_waitcnt vmcnt(4)
    buffer_load_dwordx4 v[184:187], v1, s[20:23], s65 offen offset:256 nt
    v_mfma_f32_16x16x32_bf16 v[36:39], v[132:135], a[60:63], v[36:39]
    v_mfma_f32_16x16x32_bf16 v[40:43], v[136:139], a[60:63], v[40:43]
    s_waitcnt vmcnt(4)
    buffer_load_dwordx4 v[188:191], v1, s[20:23], s66 offen offset:256 nt
    v_mfma_f32_16x16x32_bf16 v[44:47], v[140:143], a[60:63], v[44:47]
    v_mfma_f32_16x16x32_bf16 v[48:51], v[144:147], a[60:63], v[48:51]
    s_waitcnt vmcnt(4)
    buffer_load_dwordx4 v[192:195], v1, s[20:23], s67 offen offset:256 nt
    v_mfma_f32_16x16x32_bf16 v[52:55], v[148:151], a[60:63], v[52:55]
    v_mfma_f32_16x16x32_bf16 v[56:59], v[152:155], a[60:63], v[56:59]
    s_waitcnt vmcnt(4)
    buffer_load_dwordx4 v[196:199], v1, s[20:23], s64 offen offset:512 nt
    v_mfma_f32_16x16x32_bf16 v[60:63], v[156:159], a[60:63], v[60:63]
    v_mfma_f32_16x16x32_bf16 v[64:67], v[160:163], a[60:63], v[64:67]
    s_waitcnt vmcnt(4)
    buffer_load_dwordx4 v[200:203], v1, s[20:23], s65 offen offset:512 nt
    s_nop 3
    v_cvt_pk_bf16_f32 v72, v36, v40
    v_cvt_pk_bf16_f32 v73, v44, v48
    v_cvt_pk_bf16_f32 v74, v52, v56
    v_cvt_pk_bf16_f32 v75, v60, v64
    v_cvt_pk_bf16_f32 v76, v37, v41
    v_cvt_pk_bf16_f32 v77, v45, v49
    v_cvt_pk_bf16_f32 v78, v53, v57
    v_cvt_pk_bf16_f32 v79, v61, v65
    v_perm_b32 v100, v180, v164, s35
    v_perm_b32 v104, v180, v164, s36
    v_perm_b32 v108, v181, v165, s35
    v_perm_b32 v112, v181, v165, s36
    v_perm_b32 v116, v182, v166, s35
    v_perm_b32 v120, v182, v166, s36
    v_perm_b32 v124, v183, v167, s35
    v_perm_b32 v128, v183, v167, s36
    s_waitcnt vmcnt(4)
    buffer_load_dwordx4 v[204:207], v1, s[20:23], s66 offen offset:512 nt
    v_cvt_pk_bf16_f32 v80, v38, v42
    v_cvt_pk_bf16_f32 v81, v46, v50
    v_cvt_pk_bf16_f32 v82, v54, v58
    v_cvt_pk_bf16_f32 v83, v62, v66
    v_cvt_pk_bf16_f32 v84, v39, v43
    v_cvt_pk_bf16_f32 v85, v47, v51
    v_cvt_pk_bf16_f32 v86, v55, v59
    v_cvt_pk_bf16_f32 v87, v63, v67
    v_perm_b32 v101, v184, v168, s35
    v_perm_b32 v105, v184, v168, s36
    v_perm_b32 v109, v185, v169, s35
    v_perm_b32 v113, v185, v169, s36
    v_perm_b32 v117, v186, v170, s35
    v_perm_b32 v121, v186, v170, s36
    v_perm_b32 v125, v187, v171, s35
    v_perm_b32 v129, v187, v171, s36
    s_waitcnt vmcnt(4)
    buffer_load_dwordx4 v[208:211], v1, s[20:23], s67 offen offset:512 nt
    s_lshl_b32 s37, s32, 10
    v_lshlrev_b32 v5, 4, v2
    v_mfma_f32_16x16x32_bf16 v[68:71], v[72:75], v[20:23], 0
    v_mfma_f32_16x16x32_bf16 v[68:71], v[76:79], v[24:27], v[68:71]
    v_mfma_f32_16x16x32_bf16 v[68:71], v[80:83], v[28:31], v[68:71]
    v_mfma_f32_16x16x32_bf16 v[68:71], v[84:87], v[32:35], v[68:71]
    v_add_u32 v5, s37, v5
    v_perm_b32 v102, v188, v172, s35
    v_perm_b32 v106, v188, v172, s36
    v_perm_b32 v110, v189, v173, s35
    v_perm_b32 v114, v189, v173, s36
    v_perm_b32 v118, v190, v174, s35
    v_perm_b32 v122, v190, v174, s36
    v_perm_b32 v126, v191, v175, s35
    v_perm_b32 v130, v191, v175, s36
    s_waitcnt vmcnt(4)
    buffer_load_dwordx4 v[212:215], v1, s[20:23], s64 offen offset:768 nt
    v_perm_b32 v103, v192, v176, s35
    v_perm_b32 v107, v192, v176, s36
    v_perm_b32 v111, v193, v177, s35
    v_perm_b32 v115, v193, v177, s36
    v_perm_b32 v119, v194, v178, s35
    v_perm_b32 v123, v194, v178, s36
    v_perm_b32 v127, v195, v179, s35
    v_perm_b32 v131, v195, v179, s36
    ds_write_b128 v5, v[68:71] offset:0
    s_waitcnt vmcnt(4)
    buffer_load_dwordx4 v[216:219], v1, s[20:23], s65 offen offset:768 nt
    v_mfma_f32_16x16x32_bf16 v[36:39], a[0:3], v[100:103], 0
    v_mfma_f32_16x16x32_bf16 v[40:43], a[0:3], v[104:107], 0
    s_cbranch_vccnz L_e137
    s_waitcnt vmcnt(4)
L_e137:
    buffer_load_dwordx4 v[220:223], v1, s[20:23], s66 offen offset:768 nt
    s_waitcnt vmcnt(5)
    v_mfma_f32_16x16x32_bf16 v[44:47], a[0:3], v[108:111], 0
    v_mfma_f32_16x16x32_bf16 v[48:51], a[0:3], v[112:115], 0
    s_waitcnt vmcnt(4)
    buffer_load_dwordx4 v[224:227], v1, s[20:23], s67 offen offset:768 nt
    v_mfma_f32_16x16x32_bf16 v[52:55], a[0:3], v[116:119], 0
    v_mfma_f32_16x16x32_bf16 v[56:59], a[0:3], v[120:123], 0
    s_waitcnt vmcnt(4)
    buffer_load_dwordx4 v[164:167], v1, s[20:23], s64 offen offset:1024 nt
    v_mfma_f32_16x16x32_bf16 v[60:63], a[0:3], v[124:127], 0
    v_mfma_f32_16x16x32_bf16 v[64:67], a[0:3], v[128:131], 0
    s_waitcnt vmcnt(4)
    buffer_load_dwordx4 v[168:171], v1, s[20:23], s65 offen offset:1024 nt
    v_perm_b32 v132, v212, v196, s35
    v_perm_b32 v136, v212, v196, s36
    v_perm_b32 v140, v213, v197, s35
    v_perm_b32 v144, v213, v197, s36
    v_perm_b32 v148, v214, v198, s35
    v_perm_b32 v152, v214, v198, s36
    v_perm_b32 v156, v215, v199, s35
    v_perm_b32 v160, v215, v199, s36
    s_waitcnt vmcnt(4)
    buffer_load_dwordx4 v[172:175], v1, s[20:23], s66 offen offset:1024 nt
    v_perm_b32 v133, v216, v200, s35
    v_perm_b32 v137, v216, v200, s36
    v_perm_b32 v141, v217, v201, s35
    v_perm_b32 v145, v217, v201, s36
    v_perm_b32 v149, v218, v202, s35
    v_perm_b32 v153, v218, v202, s36
    v_perm_b32 v157, v219, v203, s35
    v_perm_b32 v161, v219, v203, s36
    s_waitcnt vmcnt(4)
    buffer_load_dwordx4 v[176:179], v1, s[20:23], s67 offen offset:1024 nt
    v_perm_b32 v134, v220, v204, s35
    v_perm_b32 v138, v220, v204, s36
    v_perm_b32 v142, v221, v205, s35
    v_perm_b32 v146, v221, v205, s36
    v_perm_b32 v150, v222, v206, s35
    v_perm_b32 v154, v222, v206, s36
    v_perm_b32 v158, v223, v207, s35
    v_perm_b32 v162, v223, v207, s36
    s_waitcnt vmcnt(4)
    buffer_load_dwordx4 v[180:183], v1, s[20:23], s64 offen offset:1280 nt
    v_perm_b32 v135, v224, v208, s35
    v_perm_b32 v139, v224, v208, s36
    v_perm_b32 v143, v225, v209, s35
    v_perm_b32 v147, v225, v209, s36
    v_perm_b32 v151, v226, v210, s35
    v_perm_b32 v155, v226, v210, s36
    v_perm_b32 v159, v227, v211, s35
    v_perm_b32 v163, v227, v211, s36
    s_waitcnt vmcnt(4)
    buffer_load_dwordx4 v[184:187], v1, s[20:23], s65 offen offset:1280 nt
    v_mfma_f32_16x16x32_bf16 v[36:39], a[4:7], v[132:135], v[36:39]
    v_mfma_f32_16x16x32_bf16 v[40:43], a[4:7], v[136:139], v[40:43]
    s_waitcnt vmcnt(4)
    buffer_load_dwordx4 v[188:191], v1, s[20:23], s66 offen offset:1280 nt
    v_mfma_f32_16x16x32_bf16 v[44:47], a[4:7], v[140:143], v[44:47]
    v_mfma_f32_16x16x32_bf16 v[48:51], a[4:7], v[144:147], v[48:51]
    s_waitcnt vmcnt(4)
    buffer_load_dwordx4 v[192:195], v1, s[20:23], s67 offen offset:1280 nt
    v_mfma_f32_16x16x32_bf16 v[52:55], a[4:7], v[148:151], v[52:55]
    v_mfma_f32_16x16x32_bf16 v[56:59], a[4:7], v[152:155], v[56:59]
    s_waitcnt vmcnt(4)
    buffer_load_dwordx4 v[196:199], v1, s[20:23], s64 offen offset:1536 nt
    v_mfma_f32_16x16x32_bf16 v[60:63], a[4:7], v[156:159], v[60:63]
    v_mfma_f32_16x16x32_bf16 v[64:67], a[4:7], v[160:163], v[64:67]
    s_waitcnt vmcnt(4)
    buffer_load_dwordx4 v[200:203], v1, s[20:23], s65 offen offset:1536 nt
    v_perm_b32 v100, v180, v164, s35
    v_perm_b32 v104, v180, v164, s36
    v_perm_b32 v108, v181, v165, s35
    v_perm_b32 v112, v181, v165, s36
    v_perm_b32 v116, v182, v166, s35
    v_perm_b32 v120, v182, v166, s36
    v_perm_b32 v124, v183, v167, s35
    v_perm_b32 v128, v183, v167, s36
    s_waitcnt vmcnt(4)
    buffer_load_dwordx4 v[204:207], v1, s[20:23], s66 offen offset:1536 nt
    v_perm_b32 v101, v184, v168, s35
    v_perm_b32 v105, v184, v168, s36
    v_perm_b32 v109, v185, v169, s35
    v_perm_b32 v113, v185, v169, s36
    v_perm_b32 v117, v186, v170, s35
    v_perm_b32 v121, v186, v170, s36
    v_perm_b32 v125, v187, v171, s35
    v_perm_b32 v129, v187, v171, s36
    s_waitcnt vmcnt(4)
    buffer_load_dwordx4 v[208:211], v1, s[20:23], s67 offen offset:1536 nt
    v_perm_b32 v102, v188, v172, s35
    v_perm_b32 v106, v188, v172, s36
    v_perm_b32 v110, v189, v173, s35
    v_perm_b32 v114, v189, v173, s36
    v_perm_b32 v118, v190, v174, s35
    v_perm_b32 v122, v190, v174, s36
    v_perm_b32 v126, v191, v175, s35
    v_perm_b32 v130, v191, v175, s36
    s_waitcnt vmcnt(4)
    buffer_load_dwordx4 v[212:215], v1, s[20:23], s64 offen offset:1792 nt
    v_perm_b32 v103, v192, v176, s35
    v_perm_b32 v107, v192, v176, s36
    v_perm_b32 v111, v193, v177, s35
    v_perm_b32 v115, v193, v177, s36
    v_perm_b32 v119, v194, v178, s35
    v_perm_b32 v123, v194, v178, s36
    v_perm_b32 v127, v195, v179, s35
    v_perm_b32 v131, v195, v179, s36
    s_waitcnt vmcnt(4)
    buffer_load_dwordx4 v[216:219], v1, s[20:23], s65 offen offset:1792 nt
    v_mfma_f32_16x16x32_bf16 v[36:39], a[8:11], v[100:103], v[36:39]
    v_mfma_f32_16x16x32_bf16 v[40:43], a[8:11], v[104:107], v[40:43]
    s_cbranch_vccnz L_e153
    s_waitcnt vmcnt(4)
L_e153:
    buffer_load_dwordx4 v[220:223], v1, s[20:23], s66 offen offset:1792 nt
    s_waitcnt vmcnt(5)
    v_mfma_f32_16x16x32_bf16 v[44:47], a[8:11], v[108:111], v[44:47]
    v_mfma_f32_16x16x32_bf16 v[48:51], a[8:11], v[112:115], v[48:51]
    s_waitcnt vmcnt(4)
    buffer_load_dwordx4 v[224:227], v1, s[20:23], s67 offen offset:1792 nt
    v_mfma_f32_16x16x32_bf16 v[52:55], a[8:11], v[116:119], v[52:55]
    v_mfma_f32_16x16x32_bf16 v[56:59], a[8:11], v[120:123], v[56:59]
    s_waitcnt vmcnt(4)
    s_add_u32 s64, s33, 131072
    buffer_load_dwordx4 v[164:167], v1, s[20:23], s64 offen offset:0 nt
    v_mfma_f32_16x16x32_bf16 v[60:63], a[8:11], v[124:127], v[60:63]
    v_mfma_f32_16x16x32_bf16 v[64:67], a[8:11], v[128:131], v[64:67]
    s_waitcnt vmcnt(4)
    s_add_u32 s65, s33, 163840
    buffer_load_dwordx4 v[168:171], v1, s[20:23], s65 offen offset:0 nt
    v_perm_b32 v132, v212, v196, s35
    v_perm_b32 v136, v212, v196, s36
    v_perm_b32 v140, v213, v197, s35
    v_perm_b32 v144, v213, v197, s36
    v_perm_b32 v148, v214, v198, s35
    v_perm_b32 v152, v214, v198, s36
    v_perm_b32 v156, v215, v199, s35
    v_perm_b32 v160, v215, v199, s36
    s_waitcnt vmcnt(4)
    s_add_u32 s66, s33, 196608
    buffer_load_dwordx4 v[172:175], v1, s[20:23], s66 offen offset:0 nt
    v_perm_b32 v133, v216, v200, s35
    v_perm_b32 v137, v216, v200, s36
    v_perm_b32 v141, v217, v201, s35
    v_perm_b32 v145, v217, v201, s36
    v_perm_b32 v149, v218, v202, s35
    v_perm_b32 v153, v218, v202, s36
    v_perm_b32 v157, v219, v203, s35
    v_perm_b32 v161, v219, v203, s36
    s_waitcnt vmcnt(4)
    s_add_u32 s67, s33, 229376
    buffer_load_dwordx4 v[176:179], v1, s[20:23], s67 offen offset:0 nt
    v_perm_b32 v134, v220, v204, s35
    v_perm_b32 v138, v220, v204, s36
    v_perm_b32 v142, v221, v205, s35
    v_perm_b32 v146, v221, v205, s36
    v_perm_b32 v150, v222, v206, s35
    v_perm_b32 v154, v222, v206, s36
    v_perm_b32 v158, v223, v207, s35
    v_perm_b32 v162, v223, v207, s36
    s_waitcnt vmcnt(4)
    buffer_load_dwordx4 v[180:183], v1, s[20:23], s64 offen offset:256 nt
    v_perm_b32 v135, v224, v208, s35
    v_perm_b32 v139, v224, v208, s36
    v_perm_b32 v143, v225, v209, s35
    v_perm_b32 v147, v225, v209, s36
    v_perm_b32 v151, v226, v210, s35
    v_perm_b32 v155, v226, v210, s36
    v_perm_b32 v159, v227, v211, s35
    v_perm_b32 v163, v227, v211, s36
    s_waitcnt vmcnt(4)
    buffer_load_dwordx4 v[184:187], v1, s[20:23], s65 offen offset:256 nt
    v_mfma_f32_16x16x32_bf16 v[36:39], a[12:15], v[132:135], v[36:39]
    v_mfma_f32_16x16x32_bf16 v[40:43], a[12:15], v[136:139], v[40:43]
    s_waitcnt vmcnt(4)
    buffer_load_dwordx4 v[188:191], v1, s[20:23], s66 offen offset:256 nt
    v_mfma_f32_16x16x32_bf16 v[44:47], a[12:15], v[140:143], v[44:47]
    v_mfma_f32_16x16x32_bf16 v[48:51], a[12:15], v[144:147], v[48:51]
    s_waitcnt vmcnt(4)
    buffer_load_dwordx4 v[192:195], v1, s[20:23], s67 offen offset:256 nt
    v_mfma_f32_16x16x32_bf16 v[52:55], a[12:15], v[148:151], v[52:55]
    v_mfma_f32_16x16x32_bf16 v[56:59], a[12:15], v[152:155], v[56:59]
    s_waitcnt vmcnt(4)
    buffer_load_dwordx4 v[196:199], v1, s[20:23], s64 offen offset:512 nt
    v_mfma_f32_16x16x32_bf16 v[60:63], a[12:15], v[156:159], v[60:63]
    v_mfma_f32_16x16x32_bf16 v[64:67], a[12:15], v[160:163], v[64:67]
    s_waitcnt vmcnt(4)
    buffer_load_dwordx4 v[200:203], v1, s[20:23], s65 offen offset:512 nt
    v_perm_b32 v100, v180, v164, s35
    v_perm_b32 v104, v180, v164, s36
    v_perm_b32 v108, v181, v165, s35
    v_perm_b32 v112, v181, v165, s36
    v_perm_b32 v116, v182, v166, s35
    v_perm_b32 v120, v182, v166, s36
    v_perm_b32 v124, v183, v167, s35
    v_perm_b32 v128, v183, v167, s36
    s_waitcnt vmcnt(4)
    buffer_load_dwordx4 v[204:207], v1, s[20:23], s66 offen offset:512 nt
    v_perm_b32 v101, v184, v168, s35
    v_perm_b32 v105, v184, v168, s36
    v_perm_b32 v109, v185, v169, s35
    v_perm_b32 v113, v185, v169, s36
    v_perm_b32 v117, v186, v170, s35
    v_perm_b32 v121, v186, v170, s36
    v_perm_b32 v125, v187, v171, s35
    v_perm_b32 v129, v187, v171, s36
    s_waitcnt vmcnt(4)
    buffer_load_dwordx4 v[208:211], v1, s[20:23], s67 offen offset:512 nt
    v_perm_b32 v102, v188, v172, s35
    v_perm_b32 v106, v188, v172, s36
    v_perm_b32 v110, v189, v173, s35
    v_perm_b32 v114, v189, v173, s36
    v_perm_b32 v118, v190, v174, s35
    v_perm_b32 v122, v190, v174, s36
    v_perm_b32 v126, v191, v175, s35
    v_perm_b32 v130, v191, v175, s36
    s_waitcnt vmcnt(4)
    buffer_load_dwordx4 v[212:215], v1, s[20:23], s64 offen offset:768 nt
    v_perm_b32 v103, v192, v176, s35
    v_perm_b32 v107, v192, v176, s36
    v_perm_b32 v111, v193, v177, s35
    v_perm_b32 v115, v193, v177, s36
    v_perm_b32 v119, v194, v178, s35
    v_perm_b32 v123, v194, v178, s36
    v_perm_b32 v127, v195, v179, s35
    v_perm_b32 v131, v195, v179, s36
    s_waitcnt vmcnt(4)
    buffer_load_dwordx4 v[216:219], v1, s[20:23], s65 offen offset:768 nt
    v_mfma_f32_16x16x32_bf16 v[36:39], a[16:19], v[100:103], v[36:39]
    v_mfma_f32_16x16x32_bf16 v[40:43], a[16:19], v[104:107], v[40:43]
    s_cbranch_vccnz L_e169
    s_waitcnt vmcnt(4)
L_e169:
    buffer_load_dwordx4 v[220:223], v1, s[20:23], s66 offen offset:768 nt
    s_waitcnt vmcnt(5)
    v_mfma_f32_16x16x32_bf16 v[44:47], a[16:19], v[108:111], v[44:47]
    v_mfma_f32_16x16x32_bf16 v[48:51], a[16:19], v[112:115], v[48:51]
    s_waitcnt vmcnt(4)
    buffer_load_dwordx4 v[224:227], v1, s[20:23], s67 offen offset:768 nt
    v_mfma_f32_16x16x32_bf16 v[52:55], a[16:19], v[116:119], v[52:55]
    v_mfma_f32_16x16x32_bf16 v[56:59], a[16:19], v[120:123], v[56:59]
    s_waitcnt vmcnt(4)
    buffer_load_dwordx4 v[164:167], v1, s[20:23], s64 offen offset:1024 nt
    v_mfma_f32_16x16x32_bf16 v[60:63], a[16:19], v[124:127], v[60:63]
    v_mfma_f32_16x16x32_bf16 v[64:67], a[16:19], v[128:131], v[64:67]
    s_waitcnt vmcnt(4)
    buffer_load_dwordx4 v[168:171], v1, s[20:23], s65 offen offset:1024 nt
    v_perm_b32 v132, v212, v196, s35
    v_perm_b32 v136, v212, v196, s36
    v_perm_b32 v140, v213, v197, s35
    v_perm_b32 v144, v213, v197, s36
    v_perm_b32 v148, v214, v198, s35
    v_perm_b32 v152, v214, v198, s36
    v_perm_b32 v156, v215, v199, s35
    v_perm_b32 v160, v215, v199, s36
    s_waitcnt vmcnt(4)
    buffer_load_dwordx4 v[172:175], v1, s[20:23], s66 offen offset:1024 nt
    v_perm_b32 v133, v216, v200, s35
    v_perm_b32 v137, v216, v200, s36
    v_perm_b32 v141, v217, v201, s35
    v_perm_b32 v145, v217, v201, s36
    v_perm_b32 v149, v218, v202, s35
    v_perm_b32 v153, v218, v202, s36
    v_perm_b32 v157, v219, v203, s35
    v_perm_b32 v161, v219, v203, s36
    s_waitcnt vmcnt(4)
    buffer_load_dwordx4 v[176:179], v1, s[20:23], s67 offen offset:1024 nt
    v_perm_b32 v134, v220, v204, s35
    v_perm_b32 v138, v220, v204, s36
    v_perm_b32 v142, v221, v205, s35
    v_perm_b32 v146, v221, v205, s36
    v_perm_b32 v150, v222, v206, s35
    v_perm_b32 v154, v222, v206, s36
    v_perm_b32 v158, v223, v207, s35
    v_perm_b32 v162, v223, v207, s36
    s_waitcnt vmcnt(4)
    buffer_load_dwordx4 v[180:183], v1, s[20:23], s64 offen offset:1280 nt
    v_perm_b32 v135, v224, v208, s35
    v_perm_b32 v139, v224, v208, s36
    v_perm_b32 v143, v225, v209, s35
    v_perm_b32 v147, v225, v209, s36
    v_perm_b32 v151, v226, v210, s35
    v_perm_b32 v155, v226, v210, s36
    v_perm_b32 v159, v227, v211, s35
    v_perm_b32 v163, v227, v211, s36
    s_waitcnt vmcnt(4)
    buffer_load_dwordx4 v[184:187], v1, s[20:23], s65 offen offset:1280 nt
    v_mfma_f32_16x16x32_bf16 v[36:39], a[20:23], v[132:135], v[36:39]
    v_mfma_f32_16x16x32_bf16 v[40:43], a[20:23], v[136:139], v[40:43]
    s_waitcnt vmcnt(4)
    buffer_load_dwordx4 v[188:191], v1, s[20:23], s66 offen offset:1280 nt
    v_mfma_f32_16x16x32_bf16 v[44:47], a[20:23], v[140:143], v[44:47]
    v_mfma_f32_16x16x32_bf16 v[48:51], a[20:23], v[144:147], v[48:51]
    s_waitcnt vmcnt(4)
    buffer_load_dwordx4 v[192:195], v1, s[20:23], s67 offen offset:1280 nt
    v_mfma_f32_16x16x32_bf16 v[52:55], a[20:23], v[148:151], v[52:55]
    v_mfma_f32_16x16x32_bf16 v[56:59], a[20:23], v[152:155], v[56:59]
    s_waitcnt vmcnt(4)
    buffer_load_dwordx4 v[196:199], v1, s[20:23], s64 offen offset:1536 nt
    v_mfma_f32_16x16x32_bf16 v[60:63], a[20:23], v[156:159], v[60:63]
    v_mfma_f32_16x16x32_bf16 v[64:67], a[20:23], v[160:163], v[64:67]
    s_waitcnt vmcnt(4)
    buffer_load_dwordx4 v[200:203], v1, s[20:23], s65 offen offset:1536 nt
    v_perm_b32 v100, v180, v164, s35
    v_perm_b32 v104, v180, v164, s36
    v_perm_b32 v108, v181, v165, s35
    v_perm_b32 v112, v181, v165, s36
    v_perm_b32 v116, v182, v166, s35
    v_perm_b32 v120, v182, v166, s36
    v_perm_b32 v124, v183, v167, s35
    v_perm_b32 v128, v183, v167, s36
    s_waitcnt vmcnt(4)
    buffer_load_dwordx4 v[204:207], v1, s[20:23], s66 offen offset:1536 nt
    v_perm_b32 v101, v184, v168, s35
    v_perm_b32 v105, v184, v168, s36
    v_perm_b32 v109, v185, v169, s35
    v_perm_b32 v113, v185, v169, s36
    v_perm_b32 v117, v186, v170, s35
    v_perm_b32 v121, v186, v170, s36
    v_perm_b32 v125, v187, v171, s35
    v_perm_b32 v129, v187, v171, s36
    s_waitcnt vmcnt(4)
    buffer_load_dwordx4 v[208:211], v1, s[20:23], s67 offen offset:1536 nt
    v_perm_b32 v102, v188, v172, s35
    v_perm_b32 v106, v188, v172, s36
    v_perm_b32 v110, v189, v173, s35
    v_perm_b32 v114, v189, v173, s36
    v_perm_b32 v118, v190, v174, s35
    v_perm_b32 v122, v190, v174, s36
    v_perm_b32 v126, v191, v175, s35
    v_perm_b32 v130, v191, v175, s36
    s_waitcnt vmcnt(4)
    buffer_load_dwordx4 v[212:215], v1, s[20:23], s64 offen offset:1792 nt
    v_perm_b32 v103, v192, v176, s35
    v_perm_b32 v107, v192, v176, s36
    v_perm_b32 v111, v193, v177, s35
    v_perm_b32 v115, v193, v177, s36
    v_perm_b32 v119, v194, v178, s35
    v_perm_b32 v123, v194, v178, s36
    v_perm_b32 v127, v195, v179, s35
    v_perm_b32 v131, v195, v179, s36
    s_waitcnt vmcnt(4)
    buffer_load_dwordx4 v[216:219], v1, s[20:23], s65 offen offset:1792 nt
    v_mfma_f32_16x16x32_bf16 v[36:39], a[24:27], v[100:103], v[36:39]
    v_mfma_f32_16x16x32_bf16 v[40:43], a[24:27], v[104:107], v[40:43]
    s_cbranch_vccnz L_e185
    s_waitcnt vmcnt(4)
L_e185:
    buffer_load_dwordx4 v[220:223], v1, s[20:23], s66 offen offset:1792 nt
    s_waitcnt vmcnt(5)
    v_mfma_f32_16x16x32_bf16 v[44:47], a[24:27], v[108:111], v[44:47]
    v_mfma_f32_16x16x32_bf16 v[48:51], a[24:27], v[112:115], v[48:51]
    s_waitcnt vmcnt(4)
    buffer_load_dwordx4 v[224:227], v1, s[20:23], s67 offen offset:1792 nt
    v_mfma_f32_16x16x32_bf16 v[52:55], a[24:27], v[116:119], v[52:55]
    v_mfma_f32_16x16x32_bf16 v[56:59], a[24:27], v[120:123], v[56:59]
    s_waitcnt vmcnt(4)
    s_add_u32 s64, s33, 262144
    buffer_load_dwordx4 v[164:167], v1, s[20:23], s64 offen offset:0 nt
    v_mfma_f32_16x16x32_bf16 v[60:63], a[24:27], v[124:127], v[60:63]
    v_mfma_f32_16x16x32_bf16 v[64:67], a[24:27], v[128:131], v[64:67]
    s_waitcnt vmcnt(4)
    s_add_u32 s65, s33, 294912
    buffer_load_dwordx4 v[168:171], v1, s[20:23], s65 offen offset:0 nt
    v_perm_b32 v132, v212, v196, s35
    v_perm_b32 v136, v212, v196, s36
    v_perm_b32 v140, v213, v197, s35
    v_perm_b32 v144, v213, v197, s36
    v_perm_b32 v148, v214, v198, s35
    v_perm_b32 v152, v214, v198, s36
    v_perm_b32 v156, v215, v199, s35
    v_perm_b32 v160, v215, v199, s36
    s_waitcnt vmcnt(4)
    s_add_u32 s66, s33, 327680
    buffer_load_dwordx4 v[172:175], v1, s[20:23], s66 offen offset:0 nt
    v_perm_b32 v133, v216, v200, s35
    v_perm_b32 v137, v216, v200, s36
    v_perm_b32 v141, v217, v201, s35
    v_perm_b32 v145, v217, v201, s36
    v_perm_b32 v149, v218, v202, s35
    v_perm_b32 v153, v218, v202, s36
    v_perm_b32 v157, v219, v203, s35
    v_perm_b32 v161, v219, v203, s36
    s_waitcnt vmcnt(4)
    s_add_u32 s67, s33, 360448
    buffer_load_dwordx4 v[176:179], v1, s[20:23], s67 offen offset:0 nt
    v_perm_b32 v134, v220, v204, s35
    v_perm_b32 v138, v220, v204, s36
    v_perm_b32 v142, v221, v205, s35
    v_perm_b32 v146, v221, v205, s36
    v_perm_b32 v150, v222, v206, s35
    v_perm_b32 v154, v222, v206, s36
    v_perm_b32 v158, v223, v207, s35
    v_perm_b32 v162, v223, v207, s36
    s_waitcnt vmcnt(4)
    buffer_load_dwordx4 v[180:183], v1, s[20:23], s64 offen offset:256 nt
    v_perm_b32 v135, v224, v208, s35
    v_perm_b32 v139, v224, v208, s36
    v_perm_b32 v143, v225, v209, s35
    v_perm_b32 v147, v225, v209, s36
    v_perm_b32 v151, v226, v210, s35
    v_perm_b32 v155, v226, v210, s36
    v_perm_b32 v159, v227, v211, s35
    v_perm_b32 v163, v227, v211, s36
    s_waitcnt vmcnt(4)
    buffer_load_dwordx4 v[184:187], v1, s[20:23], s65 offen offset:256 nt
    v_mfma_f32_16x16x32_bf16 v[36:39], a[28:31], v[132:135], v[36:39]
    v_mfma_f32_16x16x32_bf16 v[40:43], a[28:31], v[136:139], v[40:43]
    s_waitcnt vmcnt(4)
    buffer_load_dwordx4 v[188:191], v1, s[20:23], s66 offen offset:256 nt
    v_mfma_f32_16x16x32_bf16 v[44:47], a[28:31], v[140:143], v[44:47]
    v_mfma_f32_16x16x32_bf16 v[48:51], a[28:31], v[144:147], v[48:51]
    s_waitcnt vmcnt(4)
    buffer_load_dwordx4 v[192:195], v1, s[20:23], s67 offen offset:256 nt
    v_mfma_f32_16x16x32_bf16 v[52:55], a[28:31], v[148:151], v[52:55]
    v_mfma_f32_16x16x32_bf16 v[56:59], a[28:31], v[152:155], v[56:59]
    s_waitcnt vmcnt(4)
    buffer_load_dwordx4 v[196:199], v1, s[20:23], s64 offen offset:512 nt
    v_mfma_f32_16x16x32_bf16 v[60:63], a[28:31], v[156:159], v[60:63]
    v_mfma_f32_16x16x32_bf16 v[64:67], a[28:31], v[160:163], v[64:67]
    s_waitcnt vmcnt(4)
    buffer_load_dwordx4 v[200:203], v1, s[20:23], s65 offen offset:512 nt
    v_perm_b32 v100, v180, v164, s35
    v_perm_b32 v104, v180, v164, s36
    v_perm_b32 v108, v181, v165, s35
    v_perm_b32 v112, v181, v165, s36
    v_perm_b32 v116, v182, v166, s35
    v_perm_b32 v120, v182, v166, s36
    v_perm_b32 v124, v183, v167, s35
    v_perm_b32 v128, v183, v167, s36
    s_waitcnt vmcnt(4)
    buffer_load_dwordx4 v[204:207], v1, s[20:23], s66 offen offset:512 nt
    v_perm_b32 v101, v184, v168, s35
    v_perm_b32 v105, v184, v168, s36
    v_perm_b32 v109, v185, v169, s35
    v_perm_b32 v113, v185, v169, s36
    v_perm_b32 v117, v186, v170, s35
    v_perm_b32 v121, v186, v170, s36
    v_perm_b32 v125, v187, v171, s35
    v_perm_b32 v129, v187, v171, s36
    s_waitcnt vmcnt(4)
    buffer_load_dwordx4 v[208:211], v1, s[20:23], s67 offen offset:512 nt
    v_perm_b32 v102, v188, v172, s35
    v_perm_b32 v106, v188, v172, s36
    v_perm_b32 v110, v189, v173, s35
    v_perm_b32 v114, v189, v173, s36
    v_perm_b32 v118, v190, v174, s35
    v_perm_b32 v122, v190, v174, s36
    v_perm_b32 v126, v191, v175, s35
    v_perm_b32 v130, v191, v175, s36
    s_waitcnt vmcnt(4)
    buffer_load_dwordx4 v[212:215], v1, s[20:23], s64 offen offset:768 nt
    v_perm_b32 v103, v192, v176, s35
    v_perm_b32 v107, v192, v176, s36
    v_perm_b32 v111, v193, v177, s35
    v_perm_b32 v115, v193, v177, s36
    v_perm_b32 v119, v194, v178, s35
    v_perm_b32 v123, v194, v178, s36
    v_perm_b32 v127, v195, v179, s35
    v_perm_b32 v131, v195, v179, s36
    s_waitcnt vmcnt(4)
    buffer_load_dwordx4 v[216:219], v1, s[20:23], s65 offen offset:768 nt
    v_mfma_f32_16x16x32_bf16 v[36:39], a[32:35], v[100:103], v[36:39]
    v_mfma_f32_16x16x32_bf16 v[40:43], a[32:35], v[104:107], v[40:43]
    s_cbranch_vccnz L_e201
    s_waitcnt vmcnt(4)
L_e201:
    buffer_load_dwordx4 v[220:223], v1, s[20:23], s66 offen offset:768 nt
    s_waitcnt vmcnt(5)
    v_mfma_f32_16x16x32_bf16 v[44:47], a[32:35], v[108:111], v[44:47]
    v_mfma_f32_16x16x32_bf16 v[48:51], a[32:35], v[112:115], v[48:51]
    s_waitcnt vmcnt(4)
    buffer_load_dwordx4 v[224:227], v1, s[20:23], s67 offen offset:768 nt
    v_mfma_f32_16x16x32_bf16 v[52:55], a[32:35], v[116:119], v[52:55]
    v_mfma_f32_16x16x32_bf16 v[56:59], a[32:35], v[120:123], v[56:59]
    s_waitcnt vmcnt(4)
    buffer_load_dwordx4 v[164:167], v1, s[20:23], s64 offen offset:1024 nt
    v_mfma_f32_16x16x32_bf16 v[60:63], a[32:35], v[124:127], v[60:63]
    v_mfma_f32_16x16x32_bf16 v[64:67], a[32:35], v[128:131], v[64:67]
    s_waitcnt vmcnt(4)
    buffer_load_dwordx4 v[168:171], v1, s[20:23], s65 offen offset:1024 nt
    v_perm_b32 v132, v212, v196, s35
    v_perm_b32 v136, v212, v196, s36
    v_perm_b32 v140, v213, v197, s35
    v_perm_b32 v144, v213, v197, s36
    v_perm_b32 v148, v214, v198, s35
    v_perm_b32 v152, v214, v198, s36
    v_perm_b32 v156, v215, v199, s35
    v_perm_b32 v160, v215, v199, s36
    s_waitcnt vmcnt(4)
    buffer_load_dwordx4 v[172:175], v1, s[20:23], s66 offen offset:1024 nt
    v_perm_b32 v133, v216, v200, s35
    v_perm_b32 v137, v216, v200, s36
    v_perm_b32 v141, v217, v201, s35
    v_perm_b32 v145, v217, v201, s36
    v_perm_b32 v149, v218, v202, s35
    v_perm_b32 v153, v218, v202, s36
    v_perm_b32 v157, v219, v203, s35
    v_perm_b32 v161, v219, v203, s36
    s_waitcnt vmcnt(4)
    buffer_load_dwordx4 v[176:179], v1, s[20:23], s67 offen offset:1024 nt
    v_perm_b32 v134, v220, v204, s35
    v_perm_b32 v138, v220, v204, s36
    v_perm_b32 v142, v221, v205, s35
    v_perm_b32 v146, v221, v205, s36
    v_perm_b32 v150, v222, v206, s35
    v_perm_b32 v154, v222, v206, s36
    v_perm_b32 v158, v223, v207, s35
    v_perm_b32 v162, v223, v207, s36
    s_waitcnt vmcnt(4)
    buffer_load_dwordx4 v[180:183], v1, s[20:23], s64 offen offset:1280 nt
    v_perm_b32 v135, v224, v208, s35
    v_perm_b32 v139, v224, v208, s36
    v_perm_b32 v143, v225, v209, s35
    v_perm_b32 v147, v225, v209, s36
    v_perm_b32 v151, v226, v210, s35
    v_perm_b32 v155, v226, v210, s36
    v_perm_b32 v159, v227, v211, s35
    v_perm_b32 v163, v227, v211, s36
    s_waitcnt vmcnt(4)
    buffer_load_dwordx4 v[184:187], v1, s[20:23], s65 offen offset:1280 nt
    v_mfma_f32_16x16x32_bf16 v[36:39], a[36:39], v[132:135], v[36:39]
    v_mfma_f32_16x16x32_bf16 v[40:43], a[36:39], v[136:139], v[40:43]
    s_waitcnt vmcnt(4)
    buffer_load_dwordx4 v[188:191], v1, s[20:23], s66 offen offset:1280 nt
    v_mfma_f32_16x16x32_bf16 v[44:47], a[36:39], v[140:143], v[44:47]
    v_mfma_f32_16x16x32_bf16 v[48:51], a[36:39], v[144:147], v[48:51]
    s_waitcnt vmcnt(4)
    buffer_load_dwordx4 v[192:195], v1, s[20:23], s67 offen offset:1280 nt
    v_mfma_f32_16x16x32_bf16 v[52:55], a[36:39], v[148:151], v[52:55]
    v_mfma_f32_16x16x32_bf16 v[56:59], a[36:39], v[152:155], v[56:59]
    s_waitcnt vmcnt(4)
    buffer_load_dwordx4 v[196:199], v1, s[20:23], s64 offen offset:1536 nt
    v_mfma_f32_16x16x32_bf16 v[60:63], a[36:39], v[156:159], v[60:63]
    v_mfma_f32_16x16x32_bf16 v[64:67], a[36:39], v[160:163], v[64:67]
    s_waitcnt vmcnt(4)
    buffer_load_dwordx4 v[200:203], v1, s[20:23], s65 offen offset:1536 nt
    v_perm_b32 v100, v180, v164, s35
    v_perm_b32 v104, v180, v164, s36
    v_perm_b32 v108, v181, v165, s35
    v_perm_b32 v112, v181, v165, s36
    v_perm_b32 v116, v182, v166, s35
    v_perm_b32 v120, v182, v166, s36
    v_perm_b32 v124, v183, v167, s35
    v_perm_b32 v128, v183, v167, s36
    s_waitcnt vmcnt(4)
    buffer_load_dwordx4 v[204:207], v1, s[20:23], s66 offen offset:1536 nt
    v_perm_b32 v101, v184, v168, s35
    v_perm_b32 v105, v184, v168, s36
    v_perm_b32 v109, v185, v169, s35
    v_perm_b32 v113, v185, v169, s36
    v_perm_b32 v117, v186, v170, s35
    v_perm_b32 v121, v186, v170, s36
    v_perm_b32 v125, v187, v171, s35
    v_perm_b32 v129, v187, v171, s36
    s_waitcnt vmcnt(4)
    buffer_load_dwordx4 v[208:211], v1, s[20:23], s67 offen offset:1536 nt
    v_perm_b32 v102, v188, v172, s35
    v_perm_b32 v106, v188, v172, s36
    v_perm_b32 v110, v189, v173, s35
    v_perm_b32 v114, v189, v173, s36
    v_perm_b32 v118, v190, v174, s35
    v_perm_b32 v122, v190, v174, s36
    v_perm_b32 v126, v191, v175, s35
    v_perm_b32 v130, v191, v175, s36
    s_waitcnt vmcnt(4)
    buffer_load_dwordx4 v[212:215], v1, s[20:23], s64 offen offset:1792 nt
    v_perm_b32 v103, v192, v176, s35
    v_perm_b32 v107, v192, v176, s36
    v_perm_b32 v111, v193, v177, s35
    v_perm_b32 v115, v193, v177, s36
    v_perm_b32 v119, v194, v178, s35
    v_perm_b32 v123, v194, v178, s36
    v_perm_b32 v127, v195, v179, s35
    v_perm_b32 v131, v195, v179, s36
    s_waitcnt vmcnt(4)
    buffer_load_dwordx4 v[216:219], v1, s[20:23], s65 offen offset:1792 nt
    v_mfma_f32_16x16x32_bf16 v[36:39], a[40:43], v[100:103], v[36:39]
    v_mfma_f32_16x16x32_bf16 v[40:43], a[40:43], v[104:107], v[40:43]
    s_cbranch_vccnz L_e217
    s_waitcnt vmcnt(4)
L_e217:
    buffer_load_dwordx4 v[220:223], v1, s[20:23], s66 offen offset:1792 nt
    s_waitcnt vmcnt(5)
    v_mfma_f32_16x16x32_bf16 v[44:47], a[40:43], v[108:111], v[44:47]
    v_mfma_f32_16x16x32_bf16 v[48:51], a[40:43], v[112:115], v[48:51]
    s_waitcnt vmcnt(4)
    buffer_load_dwordx4 v[224:227], v1, s[20:23], s67 offen offset:1792 nt
    v_mfma_f32_16x16x32_bf16 v[52:55], a[40:43], v[116:119], v[52:55]
    v_mfma_f32_16x16x32_bf16 v[56:59], a[40:43], v[120:123], v[56:59]
    s_waitcnt vmcnt(4)
    s_add_u32 s64, s33, 393216
    buffer_load_dwordx4 v[164:167], v1, s[20:23], s64 offen offset:0 nt
    v_mfma_f32_16x16x32_bf16 v[60:63], a[40:43], v[124:127], v[60:63]
    v_mfma_f32_16x16x32_bf16 v[64:67], a[40:43], v[128:131], v[64:67]
    s_waitcnt vmcnt(4)
    s_add_u32 s65, s33, 425984
    buffer_load_dwordx4 v[168:171], v1, s[20:23], s65 offen offset:0 nt
    v_perm_b32 v132, v212, v196, s35
    v_perm_b32 v136, v212, v196, s36
    v_perm_b32 v140, v213, v197, s35
    v_perm_b32 v144, v213, v197, s36
    v_perm_b32 v148, v214, v198, s35
    v_perm_b32 v152, v214, v198, s36
    v_perm_b32 v156, v215, v199, s35
    v_perm_b32 v160, v215, v199, s36
    s_waitcnt vmcnt(4)
    s_add_u32 s66, s33, 458752
    buffer_load_dwordx4 v[172:175], v1, s[20:23], s66 offen offset:0 nt
    v_perm_b32 v133, v216, v200, s35
    v_perm_b32 v137, v216, v200, s36
    v_perm_b32 v141, v217, v201, s35
    v_perm_b32 v145, v217, v201, s36
    v_perm_b32 v149, v218, v202, s35
    v_perm_b32 v153, v218, v202, s36
    v_perm_b32 v157, v219, v203, s35
    v_perm_b32 v161, v219, v203, s36
    s_waitcnt vmcnt(4)
    s_add_u32 s67, s33, 491520
    buffer_load_dwordx4 v[176:179], v1, s[20:23], s67 offen offset:0 nt
    v_perm_b32 v134, v220, v204, s35
    v_perm_b32 v138, v220, v204, s36
    v_perm_b32 v142, v221, v205, s35
    v_perm_b32 v146, v221, v205, s36
    v_perm_b32 v150, v222, v206, s35
    v_perm_b32 v154, v222, v206, s36
    v_perm_b32 v158, v223, v207, s35
    v_perm_b32 v162, v223, v207, s36
    s_waitcnt vmcnt(4)
    buffer_load_dwordx4 v[180:183], v1, s[20:23], s64 offen offset:256 nt
    v_perm_b32 v135, v224, v208, s35
    v_perm_b32 v139, v224, v208, s36
    v_perm_b32 v143, v225, v209, s35
    v_perm_b32 v147, v225, v209, s36
    v_perm_b32 v151, v226, v210, s35
    v_perm_b32 v155, v226, v210, s36
    v_perm_b32 v159, v227, v211, s35
    v_perm_b32 v163, v227, v211, s36
    s_waitcnt vmcnt(4)
    buffer_load_dwordx4 v[184:187], v1, s[20:23], s65 offen offset:256 nt
    v_mfma_f32_16x16x32_bf16 v[36:39], a[44:47], v[132:135], v[36:39]
    v_mfma_f32_16x16x32_bf16 v[40:43], a[44:47], v[136:139], v[40:43]
    s_waitcnt vmcnt(4)
    buffer_load_dwordx4 v[188:191], v1, s[20:23], s66 offen offset:256 nt
    v_mfma_f32_16x16x32_bf16 v[44:47], a[44:47], v[140:143], v[44:47]
    v_mfma_f32_16x16x32_bf16 v[48:51], a[44:47], v[144:147], v[48:51]
    s_waitcnt vmcnt(4)
    buffer_load_dwordx4 v[192:195], v1, s[20:23], s67 offen offset:256 nt
    v_mfma_f32_16x16x32_bf16 v[52:55], a[44:47], v[148:151], v[52:55]
    v_mfma_f32_16x16x32_bf16 v[56:59], a[44:47], v[152:155], v[56:59]
    s_waitcnt vmcnt(4)
    buffer_load_dwordx4 v[196:199], v1, s[20:23], s64 offen offset:512 nt
    v_mfma_f32_16x16x32_bf16 v[60:63], a[44:47], v[156:159], v[60:63]
    v_mfma_f32_16x16x32_bf16 v[64:67], a[44:47], v[160:163], v[64:67]
    s_waitcnt vmcnt(4)
    buffer_load_dwordx4 v[200:203], v1, s[20:23], s65 offen offset:512 nt
    v_perm_b32 v100, v180, v164, s35
    v_perm_b32 v104, v180, v164, s36
    v_perm_b32 v108, v181, v165, s35
    v_perm_b32 v112, v181, v165, s36
    v_perm_b32 v116, v182, v166, s35
    v_perm_b32 v120, v182, v166, s36
    v_perm_b32 v124, v183, v167, s35
    v_perm_b32 v128, v183, v167, s36
    s_waitcnt vmcnt(4)
    buffer_load_dwordx4 v[204:207], v1, s[20:23], s66 offen offset:512 nt
    v_perm_b32 v101, v184, v168, s35
    v_perm_b32 v105, v184, v168, s36
    v_perm_b32 v109, v185, v169, s35
    v_perm_b32 v113, v185, v169, s36
    v_perm_b32 v117, v186, v170, s35
    v_perm_b32 v121, v186, v170, s36
    v_perm_b32 v125, v187, v171, s35
    v_perm_b32 v129, v187, v171, s36
    s_waitcnt vmcnt(4)
    buffer_load_dwordx4 v[208:211], v1, s[20:23], s67 offen offset:512 nt
    v_perm_b32 v102, v188, v172, s35
    v_perm_b32 v106, v188, v172, s36
    v_perm_b32 v110, v189, v173, s35
    v_perm_b32 v114, v189, v173, s36
    v_perm_b32 v118, v190, v174, s35
    v_perm_b32 v122, v190, v174, s36
    v_perm_b32 v126, v191, v175, s35
    v_perm_b32 v130, v191, v175, s36
    s_waitcnt vmcnt(4)
    buffer_load_dwordx4 v[212:215], v1, s[20:23], s64 offen offset:768 nt
    v_perm_b32 v103, v192, v176, s35
    v_perm_b32 v107, v192, v176, s36
    v_perm_b32 v111, v193, v177, s35
    v_perm_b32 v115, v193, v177, s36
    v_perm_b32 v119, v194, v178, s35
    v_perm_b32 v123, v194, v178, s36
    v_perm_b32 v127, v195, v179, s35
    v_perm_b32 v131, v195, v179, s36
    s_waitcnt vmcnt(4)
    buffer_load_dwordx4 v[216:219], v1, s[20:23], s65 offen offset:768 nt
    v_mfma_f32_16x16x32_bf16 v[36:39], a[48:51], v[100:103], v[36:39]
    v_mfma_f32_16x16x32_bf16 v[40:43], a[48:51], v[104:107], v[40:43]
    s_cbranch_vccnz L_e233
    s_waitcnt vmcnt(4)
L_e233:
    buffer_load_dwordx4 v[220:223], v1, s[20:23], s66 offen offset:768 nt
    s_waitcnt vmcnt(5)
    v_mfma_f32_16x16x32_bf16 v[44:47], a[48:51], v[108:111], v[44:47]
    v_mfma_f32_16x16x32_bf16 v[48:51], a[48:51], v[112:115], v[48:51]
    s_waitcnt vmcnt(4)
    buffer_load_dwordx4 v[224:227], v1, s[20:23], s67 offen offset:768 nt
    v_mfma_f32_16x16x32_bf16 v[52:55], a[48:51], v[116:119], v[52:55]
    v_mfma_f32_16x16x32_bf16 v[56:59], a[48:51], v[120:123], v[56:59]
    s_waitcnt vmcnt(4)
    buffer_load_dwordx4 v[164:167], v1, s[20:23], s64 offen offset:1024 nt
    v_mfma_f32_16x16x32_bf16 v[60:63], a[48:51], v[124:127], v[60:63]
    v_mfma_f32_16x16x32_bf16 v[64:67], a[48:51], v[128:131], v[64:67]
    s_waitcnt vmcnt(4)
    buffer_load_dwordx4 v[168:171], v1, s[20:23], s65 offen offset:1024 nt
    v_perm_b32 v132, v212, v196, s35
    v_perm_b32 v136, v212, v196, s36
    v_perm_b32 v140, v213, v197, s35
    v_perm_b32 v144, v213, v197, s36
    v_perm_b32 v148, v214, v198, s35
    v_perm_b32 v152, v214, v198, s36
    v_perm_b32 v156, v215, v199, s35
    v_perm_b32 v160, v215, v199, s36
    s_waitcnt vmcnt(4)
    buffer_load_dwordx4 v[172:175], v1, s[20:23], s66 offen offset:1024 nt
    v_perm_b32 v133, v216, v200, s35
    v_perm_b32 v137, v216, v200, s36
    v_perm_b32 v141, v217, v201, s35
    v_perm_b32 v145, v217, v201, s36
    v_perm_b32 v149, v218, v202, s35
    v_perm_b32 v153, v218, v202, s36
    v_perm_b32 v157, v219, v203, s35
    v_perm_b32 v161, v219, v203, s36
    s_waitcnt vmcnt(4)
    buffer_load_dwordx4 v[176:179], v1, s[20:23], s67 offen offset:1024 nt
    v_perm_b32 v134, v220, v204, s35
    v_perm_b32 v138, v220, v204, s36
    v_perm_b32 v142, v221, v205, s35
    v_perm_b32 v146, v221, v205, s36
    v_perm_b32 v150, v222, v206, s35
    v_perm_b32 v154, v222, v206, s36
    v_perm_b32 v158, v223, v207, s35
    v_perm_b32 v162, v223, v207, s36
    s_waitcnt vmcnt(4)
    buffer_load_dwordx4 v[180:183], v1, s[20:23], s64 offen offset:1280 nt
    v_perm_b32 v135, v224, v208, s35
    v_perm_b32 v139, v224, v208, s36
    v_perm_b32 v143, v225, v209, s35
    v_perm_b32 v147, v225, v209, s36
    v_perm_b32 v151, v226, v210, s35
    v_perm_b32 v155, v226, v210, s36
    v_perm_b32 v159, v227, v211, s35
    v_perm_b32 v163, v227, v211, s36
    s_waitcnt vmcnt(4)
    buffer_load_dwordx4 v[184:187], v1, s[20:23], s65 offen offset:1280 nt
    v_mfma_f32_16x16x32_bf16 v[36:39], a[52:55], v[132:135], v[36:39]
    v_mfma_f32_16x16x32_bf16 v[40:43], a[52:55], v[136:139], v[40:43]
    s_waitcnt vmcnt(4)
    buffer_load_dwordx4 v[188:191], v1, s[20:23], s66 offen offset:1280 nt
    v_mfma_f32_16x16x32_bf16 v[44:47], a[52:55], v[140:143], v[44:47]
    v_mfma_f32_16x16x32_bf16 v[48:51], a[52:55], v[144:147], v[48:51]
    s_waitcnt vmcnt(4)
    buffer_load_dwordx4 v[192:195], v1, s[20:23], s67 offen offset:1280 nt
    v_mfma_f32_16x16x32_bf16 v[52:55], a[52:55], v[148:151], v[52:55]
    v_mfma_f32_16x16x32_bf16 v[56:59], a[52:55], v[152:155], v[56:59]
    s_waitcnt vmcnt(4)
    buffer_load_dwordx4 v[196:199], v1, s[20:23], s64 offen offset:1536 nt
    buffer_load_dwordx4 v[200:203], v1, s[20:23], s65 offen offset:1536 nt
    buffer_load_dwordx4 v[204:207], v1, s[20:23], s66 offen offset:1536 nt
    buffer_load_dwordx4 v[208:211], v1, s[20:23], s67 offen offset:1536 nt
    buffer_load_dwordx4 v[212:215], v1, s[20:23], s64 offen offset:1792 nt
    buffer_load_dwordx4 v[216:219], v1, s[20:23], s65 offen offset:1792 nt
    buffer_load_dwordx4 v[220:223], v1, s[20:23], s66 offen offset:1792 nt
    buffer_load_dwordx4 v[224:227], v1, s[20:23], s67 offen offset:1792 nt
    s_waitcnt lgkmcnt(0)
    s_barrier
    v_and_b32 v5, 7, v2
    v_lshlrev_b32 v5, 4, v5
    ds_read_b128 v[68:71], v5 offset:0
    ds_read_b128 v[72:75], v5 offset:256
    ds_read_b128 v[76:79], v5 offset:1024
    ds_read_b128 v[80:83], v5 offset:1280
    ds_read_b128 v[84:87], v5 offset:2048
    ds_read_b128 v[88:91], v5 offset:2304
    ds_read_b128 v[92:95], v5 offset:3072
    ds_read_b128 v[96:99], v5 offset:3328
    s_waitcnt lgkmcnt(0)
    v_add_f32 v68, v68, v76
    v_add_f32 v84, v84, v92
    v_add_f32 v69, v69, v77
    v_add_f32 v85, v85, v93
    v_add_f32 v70, v70, v78
    v_add_f32 v86, v86, v94
    v_add_f32 v71, v71, v79
    v_add_f32 v87, v87, v95
    v_add_f32 v72, v72, v80
    v_add_f32 v88, v88, v96
    v_add_f32 v73, v73, v81
    v_add_f32 v89, v89, v97
    v_add_f32 v74, v74, v82
    v_add_f32 v90, v90, v98
    v_add_f32 v75, v75, v83
    v_add_f32 v91, v91, v99
    v_add_f32 v20, v68, v84
    v_add_f32 v21, v69, v85
    v_add_f32 v22, v70, v86
    v_add_f32 v23, v71, v87
    v_add_f32 v24, v72, v88
    v_add_f32 v25, v73, v89
    v_add_f32 v26, v74, v90
    v_add_f32 v27, v75, v91
    v_max3_f32 v28, v20, v21, v22
    v_max3_f32 v28, v28, v23, v24
    v_max3_f32 v28, v28, v25, v26
    v_max_f32 v28, v28, v27
    s_mov_b32 s37, 0x3e0293ee
    v_sub_f32 v20, v20, v28
    v_sub_f32 v21, v21, v28
    v_sub_f32 v22, v22, v28
    v_sub_f32 v23, v23, v28
    v_sub_f32 v24, v24, v28
    v_sub_f32 v25, v25, v28
    v_sub_f32 v26, v26, v28
    v_sub_f32 v27, v27, v28
    v_mul_f32 v20, s37, v20
    v_mul_f32 v21, s37, v21
    v_mul_f32 v22, s37, v22
    v_mul_f32 v23, s37, v23
    v_mul_f32 v24, s37, v24
    v_mul_f32 v25, s37, v25
    v_mul_f32 v26, s37, v26
    v_mul_f32 v27, s37, v27
    v_exp_f32 v20, v20
    v_exp_f32 v21, v21
    v_exp_f32 v22, v22
    v_exp_f32 v23, v23
    v_exp_f32 v24, v24
    v_exp_f32 v25, v25
    v_exp_f32 v26, v26
    v_exp_f32 v27, v27
    s_nop 0
    v_add_f32 v28, v20, v21
    v_add_f32 v29, v22, v23
    v_add_f32 v30, v24, v25
    v_add_f32 v31, v26, v27
    v_add_f32 v28, v28, v29
    v_add_f32 v30, v30, v31
    v_add_f32 v28, v28, v30
    v_rcp_f32 v28, v28
    s_nop 0
    v_mul_f32 v20, v20, v28
    v_mul_f32 v21, v21, v28
    v_mul_f32 v22, v22, v28
    v_mul_f32 v23, v23, v28
    v_mul_f32 v24, v24, v28
    v_mul_f32 v25, v25, v28
    v_mul_f32 v26, v26, v28
    v_mul_f32 v27, v27, v28
    v_cvt_pk_bf16_f32 v16, v20, v21
    v_cvt_pk_bf16_f32 v17, v22, v23
    v_cvt_pk_bf16_f32 v18, v24, v25
    v_cvt_pk_bf16_f32 v19, v26, v27
    v_mfma_f32_16x16x32_bf16 v[60:63], a[52:55], v[156:159], v[60:63]
    v_mfma_f32_16x16x32_bf16 v[64:67], a[52:55], v[160:163], v[64:67]
    s_waitcnt vmcnt(11)
    v_perm_b32 v100, v180, v164, s35
    v_perm_b32 v104, v180, v164, s36
    v_perm_b32 v108, v181, v165, s35
    v_perm_b32 v112, v181, v165, s36
    v_perm_b32 v116, v182, v166, s35
    v_perm_b32 v120, v182, v166, s36
    v_perm_b32 v124, v183, v167, s35
    v_perm_b32 v128, v183, v167, s36
    s_waitcnt vmcnt(10)
    v_perm_b32 v101, v184, v168, s35
    v_perm_b32 v105, v184, v168, s36
    v_perm_b32 v109, v185, v169, s35
    v_perm_b32 v113, v185, v169, s36
    v_perm_b32 v117, v186, v170, s35
    v_perm_b32 v121, v186, v170, s36
    v_perm_b32 v125, v187, v171, s35
    v_perm_b32 v129, v187, v171, s36
    s_waitcnt vmcnt(9)
    v_perm_b32 v102, v188, v172, s35
    v_perm_b32 v106, v188, v172, s36
    v_perm_b32 v110, v189, v173, s35
    v_perm_b32 v114, v189, v173, s36
    v_perm_b32 v118, v190, v174, s35
    v_perm_b32 v122, v190, v174, s36
    v_perm_b32 v126, v191, v175, s35
    v_perm_b32 v130, v191, v175, s36
    s_waitcnt vmcnt(8)
    v_perm_b32 v103, v192, v176, s35
    v_perm_b32 v107, v192, v176, s36
    v_perm_b32 v111, v193, v177, s35
    v_perm_b32 v115, v193, v177, s36
    v_perm_b32 v119, v194, v178, s35
    v_perm_b32 v123, v194, v178, s36
    v_perm_b32 v127, v195, v179, s35
    v_perm_b32 v131, v195, v179, s36
    s_waitcnt vmcnt(7)
    v_mfma_f32_16x16x32_bf16 v[36:39], a[56:59], v[100:103], v[36:39]
    v_mfma_f32_16x16x32_bf16 v[40:43], a[56:59], v[104:107], v[40:43]
    s_waitcnt vmcnt(6)
    v_mfma_f32_16x16x32_bf16 v[44:47], a[56:59], v[108:111], v[44:47]
    v_mfma_f32_16x16x32_bf16 v[48:51], a[56:59], v[112:115], v[48:51]
    s_waitcnt vmcnt(5)
    v_mfma_f32_16x16x32_bf16 v[52:55], a[56:59], v[116:119], v[52:55]
    v_mfma_f32_16x16x32_bf16 v[56:59], a[56:59], v[120:123], v[56:59]
    s_waitcnt vmcnt(4)
    v_mfma_f32_16x16x32_bf16 v[60:63], a[56:59], v[124:127], v[60:63]
    v_mfma_f32_16x16x32_bf16 v[64:67], a[56:59], v[128:131], v[64:67]
    s_waitcnt vmcnt(3)
    v_perm_b32 v132, v212, v196, s35
    v_perm_b32 v136, v212, v196, s36
    v_perm_b32 v140, v213, v197, s35
    v_perm_b32 v144, v213, v197, s36
    v_perm_b32 v148, v214, v198, s35
    v_perm_b32 v152, v214, v198, s36
    v_perm_b32 v156, v215, v199, s35
    v_perm_b32 v160, v215, v199, s36
    s_waitcnt vmcnt(2)
    v_perm_b32 v133, v216, v200, s35
    v_perm_b32 v137, v216, v200, s36
    v_perm_b32 v141, v217, v201, s35
    v_perm_b32 v145, v217, v201, s36
    v_perm_b32 v149, v218, v202, s35
    v_perm_b32 v153, v218, v202, s36
    v_perm_b32 v157, v219, v203, s35
    v_perm_b32 v161, v219, v203, s36
    s_waitcnt vmcnt(1)
    v_perm_b32 v134, v220, v204, s35
    v_perm_b32 v138, v220, v204, s36
    v_perm_b32 v142, v221, v205, s35
    v_perm_b32 v146, v221, v205, s36
    v_perm_b32 v150, v222, v206, s35
    v_perm_b32 v154, v222, v206, s36
    v_perm_b32 v158, v223, v207, s35
    v_perm_b32 v162, v223, v207, s36
    s_waitcnt vmcnt(0)
    v_perm_b32 v135, v224, v208, s35
    v_perm_b32 v139, v224, v208, s36
    v_perm_b32 v143, v225, v209, s35
    v_mfma_f32_16x16x32_bf16 v[36:39], a[60:63], v[132:135], v[36:39]
    v_perm_b32 v147, v225, v209, s36
    v_perm_b32 v151, v226, v210, s35
    v_mfma_f32_16x16x32_bf16 v[40:43], a[60:63], v[136:139], v[40:43]
    v_perm_b32 v155, v226, v210, s36
    v_perm_b32 v159, v227, v211, s35
    v_mfma_f32_16x16x32_bf16 v[44:47], a[60:63], v[140:143], v[44:47]
    v_perm_b32 v163, v227, v211, s36
    s_nop 0
    v_mfma_f32_16x16x32_bf16 v[48:51], a[60:63], v[144:147], v[48:51]
    v_cvt_pk_bf16_f32 v68, v36, v37
    v_cvt_pk_bf16_f32 v69, v38, v39
    ds_write_b64 v10, v[68:69] offset:4096
    v_mfma_f32_16x16x32_bf16 v[52:55], a[60:63], v[148:151], v[52:55]
    v_cvt_pk_bf16_f32 v70, v40, v41
    v_cvt_pk_bf16_f32 v71, v42, v43
    ds_write_b64 v10, v[70:71] offset:4416
    v_mfma_f32_16x16x32_bf16 v[56:59], a[60:63], v[152:155], v[56:59]
    v_cvt_pk_bf16_f32 v72, v44, v45
    v_cvt_pk_bf16_f32 v73, v46, v47
    ds_write_b64 v10, v[72:73] offset:4736
    v_mfma_f32_16x16x32_bf16 v[60:63], a[60:63], v[156:159], v[60:63]
    v_cvt_pk_bf16_f32 v74, v48, v49
    v_cvt_pk_bf16_f32 v75, v50, v51
    ds_write_b64 v10, v[74:75] offset:5056
    v_mfma_f32_16x16x32_bf16 v[64:67], a[60:63], v[160:163], v[64:67]
    v_cvt_pk_bf16_f32 v76, v52, v53
    v_cvt_pk_bf16_f32 v77, v54, v55
    ds_write_b64 v10, v[76:77] offset:5376
    v_cvt_pk_bf16_f32 v78, v56, v57
    v_cvt_pk_bf16_f32 v79, v58, v59
    ds_write_b64 v10, v[78:79] offset:5696
    s_nop 0
    v_cvt_pk_bf16_f32 v80, v60, v61
    v_cvt_pk_bf16_f32 v81, v62, v63
    ds_write_b64 v10, v[80:81] offset:6016
    v_cvt_pk_bf16_f32 v82, v64, v65
    v_cvt_pk_bf16_f32 v83, v66, v67
    ds_write_b64 v10, v[82:83] offset:6336
    s_waitcnt lgkmcnt(0)
    s_barrier
    ds_read_b128 v[100:103], v11 offset:4096
    ds_read_b128 v[104:107], v11 offset:5376
    s_waitcnt lgkmcnt(1)
    v_mfma_f32_16x16x32_bf16 v[108:111], v[100:103], v[16:19], 0
    s_waitcnt lgkmcnt(0)
    v_mfma_f32_16x16x32_bf16 v[112:115], v[104:107], v[16:19], 0
    s_nop 5
    v_cvt_pk_bf16_f32 v116, v108, v109
    v_cvt_pk_bf16_f32 v117, v110, v111
    v_cvt_pk_bf16_f32 v118, v112, v113
    v_cvt_pk_bf16_f32 v119, v114, v115
    buffer_store_dwordx4 v[116:119], v12, s[28:31], 0 offen
L_end:
    s_endpgm
.section .rodata,"a"
.p2align 6
.amdhsa_kernel standalone__low_rank_proj_linformer__sampling_kernel
  .amdhsa_next_free_vgpr 292
  .amdhsa_next_free_sgpr 80
  .amdhsa_accum_offset 228
  .amdhsa_group_segment_fixed_size 0
  .amdhsa_kernarg_size 64
  .amdhsa_user_sgpr_count 2
  .amdhsa_user_sgpr_kernarg_segment_ptr 1
  .amdhsa_system_sgpr_workgroup_id_x 1
  .amdhsa_float_denorm_mode_32 3
.end_amdhsa_kernel
```
